```python
import torch

def _softmax(x, axis=-1):
    return torch.softmax(x, dim=axis)
def _gelu(x):
    return torch.nn.functional.gelu(x, approximate="tanh")
def _silu(x):
    return torch.nn.functional.silu(x)
def _sigmoid(x):
    return torch.sigmoid(x)
def _layernorm(x, axis=-1, eps=1e-5):
    m = x.mean(dim=axis, keepdim=True)
    v = x.var(dim=axis, keepdim=True, unbiased=False)
    return (x - m) / torch.sqrt(v + eps)
def _scatter_add(tgt, idx, src, axis=0):
    return tgt.clone().index_add_(axis, idx, src)
def _segment_sum(src, seg, n):
    out = torch.zeros((n,) + src.shape[1:], dtype=src.dtype)
    return out.index_add_(0, seg, src)
def _pad(x, pw):
    flat = tuple(v for pair in reversed(pw) for v in pair)
    return torch.nn.functional.pad(x, flat)

kernel_name = 'recurrent_scan__linear_attn_block__glu_gated_geglu__prompt'

def setup_inputs():

    _w = (lambda a: (lambda t: t.to(torch.bfloat16) if t.is_floating_point() else t)(torch.as_tensor(a)))
    def _A_setup():
        B, S, D = 1, 2048, 512
        return {
            "x": _w((lambda *s: torch.randn(*s, dtype=torch.bfloat16) * 0.05)(B, S, D)),
            "wqkv": _w((lambda *s: torch.randn(*s, dtype=torch.bfloat16) * 0.8)(D, 3 * D)),
            "wo": _w((lambda *s: torch.randn(*s, dtype=torch.bfloat16) * 0.8)(D, D)),
        }
    _A_in = _A_setup()

    def _B_setup():
        B, S, Dm, Df = 1, 2048, 512, 1376
        return {
            "x": _w((lambda *s: torch.randn(*s, dtype=torch.bfloat16) * 0.05)(B, S, Dm)),
            "w_gate": _w((lambda *s: torch.randn(*s, dtype=torch.bfloat16) * 0.2)(Dm, Df) * (Dm ** -0.5)),
            "w_up": _w((lambda *s: torch.randn(*s, dtype=torch.bfloat16) * 0.2)(Dm, Df) * (Dm ** -0.5)),
            "w_down": _w((lambda *s: torch.randn(*s, dtype=torch.bfloat16) * 0.2)(Df, Dm) * (Df ** -0.5)),
        }
    _B_in = _B_setup()

    return {
        "A_x": _A_in["x"],
        "A_wqkv": _A_in["wqkv"],
        "A_wo": _A_in["wo"],
        "B_x": _B_in["x"],
        "B_w_gate": _B_in["w_gate"],
        "B_w_up": _B_in["w_up"],
        "B_w_down": _B_in["w_down"],
    }

def reference(A_x, A_wqkv, A_wo, B_x, B_w_gate, B_w_up, B_w_down):
    def _A_ref(x, wqkv, wo):
        B, S, D = x.shape
        H = 32; Dh = D // H
        qkv = (lambda x, *d: x.permute(*d))((x @ wqkv).reshape(B, S, 3, H, Dh), 2, 0, 3, 1, 4)
        q, k, v = qkv[0], qkv[1], qkv[2]
        phi = lambda t: torch.where(t > 0, t + 1, torch.exp(t)) + 1e-6
        pq, pk = phi(q), phi(k)
        kv = torch.einsum("bhsd,bhse->bhde", pk, v)
        z = torch.einsum("bhsd->bhd", pk)
        num = torch.einsum("bhqd,bhde->bhqe", pq, kv)
        den = torch.einsum("bhqd,bhd->bhq", pq, z)[..., None] + 1e-6
        o = num / den
        return (lambda x, *d: x.permute(*d))(o, 0, 2, 1, 3).reshape(B, S, D) @ wo

    def _B_ref(x, w_gate, w_up, w_down):
        g = torch.einsum("bsd,df->bsf", x, w_gate)
        u = torch.einsum("bsd,df->bsf", x, w_up)
        h = _gelu(g) * u
        return torch.einsum("bsf,fd->bsd", h, w_down)

    x = A_x
    xn = _layernorm(x, axis=-1)
    s = _A_ref(xn, A_wqkv, A_wo)
    g = _silu(_B_ref(xn, B_w_gate, B_w_up, B_w_down))
    return x + s * g
```

```asm
; @launch grid=(256,1,1) block=(512,1,1) lds=163840
.amdgcn_target "amdgcn-amd-amdhsa--gfx950"
.text
.globl recurrent_scan__linear_attn_block__glu_gated_geglu__prompt_kernel
.p2align 8
.type recurrent_scan__linear_attn_block__glu_gated_geglu__prompt_kernel,@function
recurrent_scan__linear_attn_block__glu_gated_geglu__prompt_kernel:
    s_cmp_ge_u32 s2, 256
    s_cbranch_scc1 L_END
    s_load_dwordx16 s[16:31], s[0:1], 0
    s_load_dwordx2 s[32:33], s[0:1], 72
    v_lshrrev_b32 v1, 6, v0
    v_and_b32 v0, 63, v0
    v_readfirstlane_b32 s3, v1
    s_and_b32 s5, s2, 7
    s_lshr_b32 s86, s2, 3
    s_lshr_b32 s84, s5, 1
    s_lshl_b32 s84, s84, 3
    s_lshr_b32 s87, s86, 2
    s_add_u32 s84, s84, s87
    s_and_b32 s85, s5, 1
    s_lshl_b32 s85, s85, 2
    s_and_b32 s87, s86, 3
    s_add_u32 s85, s85, s87
    s_lshl_b32 s5, s5, 5
    s_add_u32 s5, s5, s86
    s_and_b32 s4, s3, 3
    s_mov_b32 s12, 0
    s_and_b32 s87, s2, 7
    s_lshl_b32 s87, s87, 2
    s_mov_b32 s88, 3703137312
    s_mov_b32 s89, 14
    s_lshr_b64 s[88:89], s[88:89], s87
    s_bfe_u32 s87, s88, 0x40004
    s_and_b32 s89, s88, 15
    s_sub_u32 s88, s5, s89
    s_add_u32 s87, s87, s86
    s_sub_u32 s87, s87, 32
    s_cmp_ge_i32 s87, s89
    s_cbranch_scc1 L_LIGHT
    s_cmp_lt_u32 s88, 132
    s_cbranch_scc0 L_BOT
    s_mul_i32 s7, s88, 171
    s_lshr_b32 s7, s7, 10
    s_mul_i32 s86, s7, 6
    s_sub_u32 s6, s88, s86
    s_branch L_FIX
L_LIGHT:
    s_lshl_b32 s87, s87, 2
    s_mov_b32 s88, 1139995120
    s_mov_b32 s89, 11110245
    s_lshr_b64 s[88:89], s[88:89], s87
    s_and_b32 s6, s88, 15
    s_mov_b32 s7, 14
    s_cmp_eq_u32 s6, 15
    s_cselect_b32 s12, 1, 0
    s_cselect_b32 s6, 0, s6
    s_cselect_b32 s7, 0, s7
    s_branch L_IDS
L_BOT:
    s_sub_u32 s86, s88, 132
    s_mul_i32 s87, s86, 205
    s_lshr_b32 s87, s87, 10
    s_sub_u32 s7, 21, s87
    s_mul_i32 s87, s87, 5
    s_sub_u32 s6, s86, s87
    s_add_u32 s6, s6, 6
L_FIX:
    s_cmp_ge_u32 s7, 14
    s_addc_u32 s7, s7, 0
L_IDS:
    s_mov_b32 s90, s7
    s_mul_i32 s8, s6, 192
    s_min_u32 s8, s8, 1856
    s_mul_i32 s9, s7, 96
    s_min_u32 s9, s9, 1280
    s_cmp_lt_u32 s3, 4
    s_cbranch_scc1 L_LOADER
    s_setprio 1
    s_getpc_b64 s[88:89]
L_PC:
    s_sub_u32 s88, s88, L_PC-recurrent_scan__linear_attn_block__glu_gated_geglu__prompt_kernel
    s_subb_u32 s89, s89, 0
    s_lshr_b32 s86, s2, 3
    s_lshl_b32 s86, s86, 3
    s_lshl_b32 s87, s4, 1
    s_add_u32 s86, s86, s87
    v_and_b32 v3, 1, v0
    v_add_u32 v3, s86, v3
    v_lshlrev_b32 v3, 7, v3
    v_min_u32 v3, L_END-recurrent_scan__linear_attn_block__glu_gated_geglu__prompt_kernel, v3
    global_load_dword v47, v3, s[88:89]
    s_lshl_b32 s86, s5, 3
    s_lshl_b32 s87, s4, 1
    s_add_u32 s86, s86, s87
    v_lshrrev_b32 v7, 5, v0
    v_add_u32 v7, s86, v7
    v_and_b32 v2, 31, v0
    v_lshlrev_b32 v2, 4, v2
    v_lshl_add_u32 v2, v7, 10, v2
    s_waitcnt lgkmcnt(0)
    s_load_dword s10, s[32:33], 0
    s_mov_b32 s36, s16
    s_mov_b32 s37, s17
    s_mov_b32 s38, 2097152
    s_mov_b32 s39, 0x20000
    buffer_load_dwordx4 v[8:11], v2, s[36:39], 0 offen
    buffer_load_dwordx4 v[12:15], v2, s[36:39], 0 offen offset:512
    s_branch L_COMPUTE
L_LOADER:
    s_cmp_ge_u32 s3, 2
    s_cbranch_scc1 L_SIDE
    s_add_u32 s79, s6, s90
    s_and_b32 s79, s79, 1
    s_lshl_b32 s79, s79, 2
    v_lshrrev_b32 v24, 3, v0
    v_and_b32 v25, 7, v0
    v_lshrrev_b32 v26, 4, v0
    v_xor_b32 v27, v25, v26
    s_mul_i32 s86, s4, 96
    s_add_u32 s86, s86, s8
    s_lshl_b32 s86, s86, 10
    v_lshl_add_u32 v16, v24, 10, s86
    v_lshl_add_u32 v16, v27, 4, v16
    v_xor_b32 v17, 64, v16
    v_add_u32 v18, 14336, v16
    v_add_u32 v19, 21504, v17
    v_add_u32 v17, 7168, v17
    s_mul_i32 s74, s4, 12288
    s_mov_b32 s86, 0
    s_lshl_b32 s70, s86, 12
    s_add_u32 s71, s70, 4096
    s_cmp_eq_u32 s71, 12288
    s_cselect_b32 s71, 0, s71
    s_add_u32 s72, s70, s71
    s_sub_u32 s72, 12288, s72
    s_lshl_b32 s86, s4, 4
    s_add_u32 s86, s86, s6
    s_cmp_eq_u32 s86, 10
    s_cselect_b32 s88, 8192, 0
    s_cmp_eq_u32 s12, 1
    s_cselect_b32 s88, 65536, s88
    s_cmp_lt_u32 s70, s88
    s_cselect_b32 s11, 0, 2097152
    s_cmp_lt_u32 s71, s88
    s_cselect_b32 s13, 0, 2097152
    s_cmp_lt_u32 s72, s88
    s_cselect_b32 s91, 0, 2097152
    s_lshl_b32 s80, s79, 7
    s_mov_b32 s88, s74
    s_waitcnt lgkmcnt(0)
    s_load_dword s10, s[32:33], 0
    s_mov_b32 s36, s16
    s_mov_b32 s37, s17
    s_mov_b32 s38, 2097152
    s_mov_b32 s39, 0x20000
    s_add_u32 m0, s88, s70
    s_lshl3_add_u32 s86, s70, s80
    s_mov_b32 s38, s11
    buffer_load_dwordx4 v16, s[36:39], s86 offen offset:0 lds
    buffer_load_dwordx4 v17, s[36:39], s86 offen offset:1024 lds
    buffer_load_dwordx4 v18, s[36:39], s86 offen offset:2048 lds
    buffer_load_dwordx4 v19, s[36:39], s86 offen offset:3072 lds
    s_add_u32 m0, s88, s71
    s_lshl3_add_u32 s86, s71, s80
    s_mov_b32 s38, s13
    buffer_load_dwordx4 v16, s[36:39], s86 offen offset:0 lds
    buffer_load_dwordx4 v17, s[36:39], s86 offen offset:1024 lds
    buffer_load_dwordx4 v18, s[36:39], s86 offen offset:2048 lds
    buffer_load_dwordx4 v19, s[36:39], s86 offen offset:3072 lds
    s_add_u32 m0, s88, s72
    s_lshl3_add_u32 s86, s72, s80
    s_mov_b32 s38, s91
    buffer_load_dwordx4 v16, s[36:39], s86 offen offset:0 lds
    buffer_load_dwordx4 v17, s[36:39], s86 offen offset:1024 lds
    buffer_load_dwordx4 v18, s[36:39], s86 offen offset:2048 lds
    buffer_load_dwordx4 v19, s[36:39], s86 offen offset:3072 lds
    s_mul_i32 s75, s4, 12288
    s_add_u32 s75, s75, 24576
    s_mov_b32 s43, 0x20000
    s_mov_b32 s78, 0
    s_cmp_ge_u32 s7, 15
    s_cbranch_scc1 L_LQKV
    s_mov_b32 s42, 1409024
    s_mov_b32 s82, 44032
    s_movk_i32 s86, 0x1556
    s_movk_i32 s87, 2752
    s_lshl_b32 s88, s9, 1
    s_cmp_eq_u32 s7, 14
    s_cselect_b32 s89, 8, 0
    s_cmp_eq_u32 s12, 1
    s_cselect_b32 s89, 12, s89
    v_mov_b32 v28, 0x80000000
    v_add_u32 v24, 0, v0
    v_mul_u32_u24 v25, s86, v24
    v_lshrrev_b32 v25, 16, v25
    v_mul_u32_u24 v26, 12, v25
    v_sub_u32 v24, v24, v26
    v_lshrrev_b32 v26, 2, v25
    v_and_b32 v26, 2, v26
    v_xor_b32 v24, v24, v26
    v_cmp_gt_u32 vcc, s89, v24
    v_mul_u32_u24 v25, s87, v25
    v_lshl_add_u32 v24, v24, 4, v25
    v_add_u32 v24, s88, v24
    v_subrev_u32 v24, 0, v24
    v_cndmask_b32 v20, v24, v28, vcc
    v_add_u32 v24, 64, v0
    v_mul_u32_u24 v25, s86, v24
    v_lshrrev_b32 v25, 16, v25
    v_mul_u32_u24 v26, 12, v25
    v_sub_u32 v24, v24, v26
    v_lshrrev_b32 v26, 2, v25
    v_and_b32 v26, 2, v26
    v_xor_b32 v24, v24, v26
    v_cmp_gt_u32 vcc, s89, v24
    v_mul_u32_u24 v25, s87, v25
    v_lshl_add_u32 v24, v24, 4, v25
    v_add_u32 v24, s88, v24
    v_subrev_u32 v24, 1024, v24
    v_cndmask_b32 v21, v24, v28, vcc
    v_add_u32 v24, 128, v0
    v_mul_u32_u24 v25, s86, v24
    v_lshrrev_b32 v25, 16, v25
    v_mul_u32_u24 v26, 12, v25
    v_sub_u32 v24, v24, v26
    v_lshrrev_b32 v26, 2, v25
    v_and_b32 v26, 2, v26
    v_xor_b32 v24, v24, v26
    v_cmp_gt_u32 vcc, s89, v24
    v_mul_u32_u24 v25, s87, v25
    v_lshl_add_u32 v24, v24, 4, v25
    v_add_u32 v24, s88, v24
    v_subrev_u32 v24, 2048, v24
    v_cndmask_b32 v22, v24, v28, vcc
    s_branch L_LGO
L_LQKV:
    s_mov_b32 s42, 1572864
    s_mov_b32 s82, 49152
    s_sub_u32 s87, s7, 15
    s_lshl_b32 s87, s87, 7
    s_mul_i32 s88, s4, 24576
    s_add_u32 s87, s87, s88
    v_mul_u32_u24 v24, 3072, v24
    v_and_b32 v26, 1, v26
    v_lshlrev_b32 v26, 2, v26
    v_xor_b32 v25, v25, v26
    s_lshl_b32 s88, s4, 1
    v_xor_b32 v25, s88, v25
    v_lshl_add_u32 v20, v25, 4, v24
    v_add_u32 v20, s87, v20
    v_mov_b32 v21, v20
    v_mov_b32 v22, v20
L_LGO:
    s_mov_b32 s87, 0
    s_add_u32 s86, s87, 0
    s_and_b32 s86, s86, 3
    s_mul_i32 s52, s86, 3072
    s_mul_i32 s73, s86, s82
    s_add_u32 s86, s87, 1
    s_and_b32 s86, s86, 3
    s_mul_i32 s53, s86, 3072
    s_mul_i32 s77, s86, s82
    s_add_u32 s86, s87, 2
    s_and_b32 s86, s86, 3
    s_mul_i32 s54, s86, 3072
    s_mul_i32 s14, s86, s82
    s_add_u32 s86, s87, 3
    s_and_b32 s86, s86, 3
    s_mul_i32 s55, s86, 3072
    s_mul_i32 s15, s86, s82
    s_cmp_eq_u32 s4, 1
    s_cselect_b32 s40, s26, s24
    s_cselect_b32 s41, s27, s25
    s_cmp_ge_u32 s7, 15
    s_cselect_b32 s40, s18, s40
    s_cselect_b32 s41, s19, s41
    s_lshl_b32 s80, s79, 7
    s_mul_i32 s81, s79, s82
    s_lshl_b32 s81, s81, 2
    s_add_u32 s88, s78, s74
    s_add_u32 s89, s78, s75
    s_add_u32 m0, s89, s52
    s_add_u32 s87, s81, s73
    buffer_load_dwordx4 v20, s[40:43], s87 offen offset:0 lds
    buffer_load_dwordx4 v21, s[40:43], s87 offen offset:1024 lds
    buffer_load_dwordx4 v22, s[40:43], s87 offen offset:2048 lds
    s_add_u32 m0, s89, s53
    s_add_u32 s87, s81, s77
    buffer_load_dwordx4 v20, s[40:43], s87 offen offset:0 lds
    buffer_load_dwordx4 v21, s[40:43], s87 offen offset:1024 lds
    buffer_load_dwordx4 v22, s[40:43], s87 offen offset:2048 lds
    s_add_u32 m0, s89, s54
    s_add_u32 s87, s81, s14
    buffer_load_dwordx4 v20, s[40:43], s87 offen offset:0 lds
    buffer_load_dwordx4 v21, s[40:43], s87 offen offset:1024 lds
    buffer_load_dwordx4 v22, s[40:43], s87 offen offset:2048 lds
    s_add_u32 m0, s89, s55
    s_add_u32 s87, s81, s15
    buffer_load_dwordx4 v20, s[40:43], s87 offen offset:0 lds
    buffer_load_dwordx4 v21, s[40:43], s87 offen offset:1024 lds
    buffer_load_dwordx4 v22, s[40:43], s87 offen offset:2048 lds
    s_add_u32 s79, s79, 1
    s_and_b32 s79, s79, 7
    s_add_u32 s78, s78, 49152
    s_cmp_eq_u32 s78, 147456
    s_cselect_b32 s78, 0, s78
    s_lshl_b32 s80, s79, 7
    s_mul_i32 s81, s79, s82
    s_lshl_b32 s81, s81, 2
    s_add_u32 s88, s78, s74
    s_add_u32 s89, s78, s75
    s_add_u32 m0, s88, s70
    s_lshl3_add_u32 s86, s70, s80
    s_mov_b32 s38, s11
    buffer_load_dwordx4 v16, s[36:39], s86 offen offset:0 lds
    buffer_load_dwordx4 v17, s[36:39], s86 offen offset:1024 lds
    buffer_load_dwordx4 v18, s[36:39], s86 offen offset:2048 lds
    buffer_load_dwordx4 v19, s[36:39], s86 offen offset:3072 lds
    s_add_u32 m0, s89, s52
    s_add_u32 s87, s81, s73
    buffer_load_dwordx4 v20, s[40:43], s87 offen offset:0 lds
    buffer_load_dwordx4 v21, s[40:43], s87 offen offset:1024 lds
    buffer_load_dwordx4 v22, s[40:43], s87 offen offset:2048 lds
    s_add_u32 m0, s88, s71
    s_lshl3_add_u32 s86, s71, s80
    s_mov_b32 s38, s13
    buffer_load_dwordx4 v16, s[36:39], s86 offen offset:0 lds
    buffer_load_dwordx4 v17, s[36:39], s86 offen offset:1024 lds
    buffer_load_dwordx4 v18, s[36:39], s86 offen offset:2048 lds
    buffer_load_dwordx4 v19, s[36:39], s86 offen offset:3072 lds
    s_add_u32 m0, s89, s53
    s_add_u32 s87, s81, s77
    buffer_load_dwordx4 v20, s[40:43], s87 offen offset:0 lds
    buffer_load_dwordx4 v21, s[40:43], s87 offen offset:1024 lds
    buffer_load_dwordx4 v22, s[40:43], s87 offen offset:2048 lds
    s_add_u32 m0, s88, s72
    s_lshl3_add_u32 s86, s72, s80
    s_mov_b32 s38, s91
    buffer_load_dwordx4 v16, s[36:39], s86 offen offset:0 lds
    buffer_load_dwordx4 v17, s[36:39], s86 offen offset:1024 lds
    buffer_load_dwordx4 v18, s[36:39], s86 offen offset:2048 lds
    buffer_load_dwordx4 v19, s[36:39], s86 offen offset:3072 lds
    s_mov_b32 s44, s32
    s_mov_b32 s45, s33
    s_mov_b32 s46, 8388608
    s_mov_b32 s47, 0x20000
    s_add_u32 s48, s32, 8388608
    s_addc_u32 s49, s33, 0
    s_mov_b32 s50, 7733248
    s_mov_b32 s51, 0x20000
    s_mov_b32 s56, s28
    s_mov_b32 s57, s29
    s_mov_b32 s58, 1409024
    s_mov_b32 s59, 0x20000
    s_mov_b32 s60, s20
    s_mov_b32 s61, s21
    s_mov_b32 s62, 524288
    s_mov_b32 s63, 0x20000
    s_mov_b32 s64, s30
    s_mov_b32 s65, s31
    s_mov_b32 s66, 2097152
    s_mov_b32 s67, 0x20000
    v_lshrrev_b32 v24, 3, v0
    v_lshlrev_b32 v24, 10, v24
    v_and_b32 v25, 7, v0
    v_bfe_u32 v26, v0, 4, 1
    v_lshlrev_b32 v26, 2, v26
    v_xor_b32 v25, v25, v26
    v_lshl_add_u32 v24, v25, 4, v24
    s_lshl_b32 s86, s85, 7
    v_add_u32 v4, s86, v24
    s_mul_i32 s87, s4, 49152
    v_add_u32 v2, s87, v4
    s_add_u32 s87, s4, 84
    s_lshl_b32 s87, s87, 14
    v_add_u32 v3, s87, v4
    s_lshl_b32 s87, s4, 17
    v_add_u32 v4, s87, v4
    s_mul_i32 s76, s4, 12288
    s_lshl_b32 s87, s84, 11
    s_mul_i32 s86, s4, 196608
    s_add_u32 s86, s86, s87
    v_lshl_add_u32 v6, v0, 4, s86
    v_bfe_u32 v24, v0, 1, 3
    v_lshlrev_b32 v24, 3, v24
    s_lshr_b32 s86, s4, 1
    s_lshl_b32 s86, s86, 2
    s_and_b32 s90, s4, 1
    s_add_u32 s86, s86, s90
    v_add_u32 v24, s86, v24
    v_min_u32 v24, 57, v24
    v_cmp_eq_u32 vcc, 56, v24
    s_nop 1
    v_cndmask_b32 v24, v24, 57, vcc
    v_and_b32 v25, 1, v0
    v_lshl_add_u32 v24, v25, 1, v24
    s_lshl_b32 s86, s4, 3
    s_add_u32 s86, s86, 44
    v_add_u32 v25, s86, v0
    v_cmp_lt_u32 vcc, 15, v0
    s_nop 1
    v_cndmask_b32 v24, v24, v25, vcc
    s_mul_i32 s86, s84, 43
    s_lshr_b32 s86, s86, 7
    s_mul_i32 s86, s86, 94208
    s_add_u32 s86, s86, 3145728
    v_lshl_add_u32 v5, v24, 10, s86
    s_add_u32 s86, s4, 84
    s_lshl_b32 s86, s86, 16
    s_add_u32 s86, s86, s87
    s_cmp_lt_u32 s4, 2
    s_cselect_b32 s86, s86, 0x80000000
    v_lshl_add_u32 v7, v0, 4, s86
    v_and_b32 v24, 3, v0
    v_bfe_u32 v25, v0, 2, 2
    v_bfe_u32 v26, v0, 4, 1
    v_lshrrev_b32 v27, 5, v0
    v_lshl_add_u32 v27, v27, 3, v25
    v_lshlrev_b32 v27, 7, v27
    v_lshrrev_b32 v25, 1, v25
    v_lshl_add_u32 v26, v25, 2, v26
    v_and_b32 v25, 1, v24
    v_lshl_add_u32 v26, v25, 1, v26
    v_lshl_add_u32 v27, v26, 4, v27
    v_lshrrev_b32 v24, 1, v24
    v_lshl_add_u32 v27, v24, 3, v27
    v_add_u32 v8, s76, v27
    v_xor_b32 v27, 64, v27
    v_add_u32 v9, s76, v27
    v_add_u32 v10, 98304, v8
    v_add_u32 v11, 98304, v9
    s_lshl_b32 s86, s4, 4
    s_lshl_b32 s87, s84, 6
    s_add_u32 s86, s86, s87
    s_add_u32 s86, s86, 0
    s_lshl_b32 s86, s86, 10
    s_lshl_b32 s87, s85, 7
    s_add_u32 s86, s86, s87
    v_lshrrev_b32 v24, 3, v0
    v_lshlrev_b32 v24, 10, v24
    v_and_b32 v25, 7, v0
    v_lshl_add_u32 v24, v25, 4, v24
    v_add_u32 v1, s86, v24
    s_mov_b32 s12, 0
    s_waitcnt lgkmcnt(0)
    s_add_u32 s10, s10, 0x9E3779B9
    s_waitcnt vmcnt(18)
    s_barrier
    s_mov_b32 s83, 0
L_LLOOP:
    s_add_u32 m0, s89, s54
    s_add_u32 s87, s81, s14
    buffer_load_dwordx4 v20, s[40:43], s87 offen offset:0 lds
    buffer_load_dwordx4 v21, s[40:43], s87 offen offset:1024 lds
    buffer_load_dwordx4 v22, s[40:43], s87 offen offset:2048 lds
    s_add_u32 m0, s89, s55
    s_add_u32 s87, s81, s15
    buffer_load_dwordx4 v20, s[40:43], s87 offen offset:0 lds
    buffer_load_dwordx4 v21, s[40:43], s87 offen offset:1024 lds
    buffer_load_dwordx4 v22, s[40:43], s87 offen offset:2048 lds
    s_add_u32 s79, s79, 1
    s_and_b32 s79, s79, 7
    s_add_u32 s78, s78, 49152
    s_cmp_eq_u32 s78, 147456
    s_cselect_b32 s78, 0, s78
    s_lshl_b32 s80, s79, 7
    s_mul_i32 s81, s79, s82
    s_lshl_b32 s81, s81, 2
    s_add_u32 s88, s78, s74
    s_add_u32 s89, s78, s75
    s_add_u32 m0, s88, s70
    s_lshl3_add_u32 s86, s70, s80
    s_mov_b32 s38, s11
    buffer_load_dwordx4 v16, s[36:39], s86 offen offset:0 lds
    buffer_load_dwordx4 v17, s[36:39], s86 offen offset:1024 lds
    buffer_load_dwordx4 v18, s[36:39], s86 offen offset:2048 lds
    buffer_load_dwordx4 v19, s[36:39], s86 offen offset:3072 lds
    s_add_u32 m0, s89, s52
    s_add_u32 s87, s81, s73
    buffer_load_dwordx4 v20, s[40:43], s87 offen offset:0 lds
    buffer_load_dwordx4 v21, s[40:43], s87 offen offset:1024 lds
    buffer_load_dwordx4 v22, s[40:43], s87 offen offset:2048 lds
    s_add_u32 m0, s88, s71
    s_lshl3_add_u32 s86, s71, s80
    s_mov_b32 s38, s13
    buffer_load_dwordx4 v16, s[36:39], s86 offen offset:0 lds
    buffer_load_dwordx4 v17, s[36:39], s86 offen offset:1024 lds
    buffer_load_dwordx4 v18, s[36:39], s86 offen offset:2048 lds
    buffer_load_dwordx4 v19, s[36:39], s86 offen offset:3072 lds
    s_add_u32 m0, s89, s53
    s_add_u32 s87, s81, s77
    buffer_load_dwordx4 v20, s[40:43], s87 offen offset:0 lds
    buffer_load_dwordx4 v21, s[40:43], s87 offen offset:1024 lds
    buffer_load_dwordx4 v22, s[40:43], s87 offen offset:2048 lds
    s_add_u32 m0, s88, s72
    s_lshl3_add_u32 s86, s72, s80
    s_mov_b32 s38, s91
    buffer_load_dwordx4 v16, s[36:39], s86 offen offset:0 lds
    buffer_load_dwordx4 v17, s[36:39], s86 offen offset:1024 lds
    buffer_load_dwordx4 v18, s[36:39], s86 offen offset:2048 lds
    buffer_load_dwordx4 v19, s[36:39], s86 offen offset:3072 lds
    s_add_u32 s83, s83, 1
    s_waitcnt vmcnt(18)
    s_barrier
    s_cmp_lt_u32 s83, 6
    s_cbranch_scc1 L_LLOOP
    s_add_u32 m0, s89, s54
    s_add_u32 s87, s81, s14
    buffer_load_dwordx4 v20, s[40:43], s87 offen offset:0 lds
    buffer_load_dwordx4 v21, s[40:43], s87 offen offset:1024 lds
    buffer_load_dwordx4 v22, s[40:43], s87 offen offset:2048 lds
    s_add_u32 m0, s89, s55
    s_add_u32 s87, s81, s15
    buffer_load_dwordx4 v20, s[40:43], s87 offen offset:0 lds
    buffer_load_dwordx4 v21, s[40:43], s87 offen offset:1024 lds
    buffer_load_dwordx4 v22, s[40:43], s87 offen offset:2048 lds
    s_mov_b32 s38, 2097152
    s_mov_b32 s86, 0
    s_mul_i32 s77, s86, 196608
    s_add_u32 s78, s77, 196608
    s_cmp_eq_u32 s78, 1376256
    s_cselect_b32 s78, 0, s78
    s_add_u32 s79, s78, 196608
    s_cmp_eq_u32 s79, 1376256
    s_cselect_b32 s79, 0, s79
    s_add_u32 s80, s79, 196608
    s_cmp_eq_u32 s80, 1376256
    s_cselect_b32 s80, 0, s80
    s_add_u32 s81, s80, 196608
    s_cmp_eq_u32 s81, 1376256
    s_cselect_b32 s81, 0, s81
    s_add_u32 s82, s81, 196608
    s_cmp_eq_u32 s82, 1376256
    s_cselect_b32 s82, 0, s82
    s_add_u32 s83, s82, 196608
    s_cmp_eq_u32 s83, 1376256
    s_cselect_b32 s83, 0, s83
    s_add_u32 m0, s76, 98304
    s_add_u32 s86, s77, 0
    s_add_u32 s87, s86, 7168
    buffer_load_dwordx4 v2, s[56:59], s86 offen lds
    buffer_load_dwordx4 v2, s[56:59], s87 offen offset:1024 lds
    s_waitcnt vmcnt(2)
    s_barrier
    s_branch L_W2
L_SIDE:
    s_add_u32 s13, s6, s90
    s_and_b32 s13, s13, 1
    s_lshl_b32 s13, s13, 2
    s_lshr_b32 s14, s6, 1
    s_add_u32 s15, s13, s14
    s_cmp_ge_u32 s6, 8
    s_cselect_b32 s14, 99, s14
    s_cmp_eq_u32 s12, 1
    s_cselect_b32 s14, 99, s14
    s_and_b32 s77, s4, 1
    v_and_b32 v24, 3, v0
    v_bfe_u32 v25, v0, 2, 2
    v_bfe_u32 v26, v0, 4, 1
    s_cmp_ge_u32 s7, 15
    s_cbranch_scc1 L_SAQ
    v_lshrrev_b32 v27, 4, v0
    v_lshl_add_u32 v27, v27, 3, v25
    v_mul_u32_u24 v27, 192, v27
    v_lshl_add_u32 v24, v24, 3, v27
    v_add_u32 v24, 24576, v24
    s_mul_i32 s87, s77, 3
    v_xor_b32 v27, s87, v26
    v_lshl_add_u32 v62, v27, 5, v24
    s_add_u32 s87, s87, 1
    v_xor_b32 v27, s87, v26
    v_lshl_add_u32 v63, v27, 5, v24
    s_branch L_SAD
L_SAQ:
    v_lshrrev_b32 v27, 5, v0
    v_mul_u32_u24 v27, 3072, v27
    v_lshl_add_u32 v27, v25, 7, v27
    v_mul_u32_u24 v28, 12320, v26
    v_lshrrev_b32 v25, 1, v25
    v_xor_b32 v25, s77, v25
    v_lshl_add_u32 v28, v25, 6, v28
    v_lshl_add_u32 v24, v24, 3, v27
    v_add_u32 v24, 24576, v24
    v_add_u32 v62, v24, v28
    v_xor_b32 v63, 32, v62
L_SAD:
    s_cmp_eq_u32 s14, 1
    s_cselect_b32 s86, 49152, 0
    s_cmp_eq_u32 s14, 2
    s_cselect_b32 s86, 98304, s86
    v_add_u32 v62, s86, v62
    v_add_u32 v63, s86, v63
    v_and_b32 v24, 16, v0
    v_cmp_ne_u32 s[72:73], 0, v24
    v_and_b32 v24, 31, v0
    s_mul_i32 s86, s77, 384
    s_add_u32 s86, s86, 151296
    v_lshrrev_b32 v25, 4, v24
    v_mul_u32_u24 v25, 128, v25
    v_lshl_add_u32 v17, v24, 2, v25
    v_add_u32 v17, s86, v17
    s_mul_i32 s87, s77, 96
    v_add_u32 v21, s87, v0
    v_add3_u32 v22, v24, s87, 64
    s_lshl_b32 s86, s8, 4
    s_add_u32 s86, s86, 65536
    v_lshl_add_u32 v19, v21, 4, s86
    v_lshl_add_u32 v20, v22, 4, s86
    s_lshl_b32 s86, s7, 13
    s_lshl_b32 s87, s77, 9
    s_add_u32 s86, s86, s87
    s_add_u32 s86, s86, 131072
    s_lshl_b32 s87, s15, 10
    s_add_u32 s74, s86, s87
    v_lshlrev_b32 v23, 4, v24
    v_lshrrev_b32 v25, 5, v0
    v_lshl_add_u32 v18, v25, 12, v23
    v_add_u32 v18, s86, v18
    v_mov_b32 v52, 0x3f803f80
    v_mov_b32 v53, 0x3f803f80
    v_mov_b32 v54, 0x3f803f80
    v_mov_b32 v55, 0x3f803f80
    s_waitcnt lgkmcnt(0)
    s_load_dword s10, s[32:33], 0
    s_mov_b32 s36, s16
    s_mov_b32 s37, s17
    s_mov_b32 s38, 2097152
    s_mov_b32 s39, 0x20000
    s_mov_b32 s44, s32
    s_mov_b32 s45, s33
    s_mov_b32 s46, 8388608
    s_mov_b32 s47, 0x20000
    s_add_u32 s48, s32, 8388608
    s_addc_u32 s49, s33, 0
    s_mov_b32 s50, 7733248
    s_mov_b32 s51, 0x20000
    s_mov_b32 s56, s28
    s_mov_b32 s57, s29
    s_mov_b32 s58, 1409024
    s_mov_b32 s59, 0x20000
    s_mov_b32 s60, s20
    s_mov_b32 s61, s21
    s_mov_b32 s62, 524288
    s_mov_b32 s63, 0x20000
    s_mov_b32 s64, s30
    s_mov_b32 s65, s31
    s_mov_b32 s66, 2097152
    s_mov_b32 s67, 0x20000
    v_lshrrev_b32 v24, 3, v0
    v_lshlrev_b32 v24, 10, v24
    v_and_b32 v25, 7, v0
    v_bfe_u32 v26, v0, 4, 1
    v_lshlrev_b32 v26, 2, v26
    v_xor_b32 v25, v25, v26
    v_lshl_add_u32 v24, v25, 4, v24
    s_lshl_b32 s86, s85, 7
    v_add_u32 v4, s86, v24
    s_mul_i32 s87, s4, 49152
    v_add_u32 v2, s87, v4
    s_add_u32 s87, s4, 84
    s_lshl_b32 s87, s87, 14
    v_add_u32 v3, s87, v4
    s_lshl_b32 s87, s4, 17
    v_add_u32 v4, s87, v4
    s_mul_i32 s76, s4, 12288
    s_lshl_b32 s87, s84, 11
    s_mul_i32 s86, s4, 196608
    s_add_u32 s86, s86, s87
    v_lshl_add_u32 v6, v0, 4, s86
    v_bfe_u32 v24, v0, 1, 3
    v_lshlrev_b32 v24, 3, v24
    s_lshr_b32 s86, s4, 1
    s_lshl_b32 s86, s86, 2
    s_and_b32 s90, s4, 1
    s_add_u32 s86, s86, s90
    v_add_u32 v24, s86, v24
    v_min_u32 v24, 57, v24
    v_cmp_eq_u32 vcc, 56, v24
    s_nop 1
    v_cndmask_b32 v24, v24, 57, vcc
    v_and_b32 v25, 1, v0
    v_lshl_add_u32 v24, v25, 1, v24
    s_lshl_b32 s86, s4, 3
    s_add_u32 s86, s86, 44
    v_add_u32 v25, s86, v0
    v_cmp_lt_u32 vcc, 15, v0
    s_nop 1
    v_cndmask_b32 v24, v24, v25, vcc
    s_mul_i32 s86, s84, 43
    s_lshr_b32 s86, s86, 7
    s_mul_i32 s86, s86, 94208
    s_add_u32 s86, s86, 3145728
    v_lshl_add_u32 v5, v24, 10, s86
    s_add_u32 s86, s4, 84
    s_lshl_b32 s86, s86, 16
    s_add_u32 s86, s86, s87
    s_cmp_lt_u32 s4, 2
    s_cselect_b32 s86, s86, 0x80000000
    v_lshl_add_u32 v7, v0, 4, s86
    v_and_b32 v24, 3, v0
    v_bfe_u32 v25, v0, 2, 2
    v_bfe_u32 v26, v0, 4, 1
    v_lshrrev_b32 v27, 5, v0
    v_lshl_add_u32 v27, v27, 3, v25
    v_lshlrev_b32 v27, 7, v27
    v_lshrrev_b32 v25, 1, v25
    v_lshl_add_u32 v26, v25, 2, v26
    v_and_b32 v25, 1, v24
    v_lshl_add_u32 v26, v25, 1, v26
    v_lshl_add_u32 v27, v26, 4, v27
    v_lshrrev_b32 v24, 1, v24
    v_lshl_add_u32 v27, v24, 3, v27
    v_add_u32 v8, s76, v27
    v_xor_b32 v27, 64, v27
    v_add_u32 v9, s76, v27
    v_add_u32 v10, 98304, v8
    v_add_u32 v11, 98304, v9
    s_lshl_b32 s86, s4, 4
    s_lshl_b32 s87, s84, 6
    s_add_u32 s86, s86, s87
    s_add_u32 s86, s86, 0
    s_lshl_b32 s86, s86, 10
    s_lshl_b32 s87, s85, 7
    s_add_u32 s86, s86, s87
    v_lshrrev_b32 v24, 3, v0
    v_lshlrev_b32 v24, 10, v24
    v_and_b32 v25, 7, v0
    v_lshl_add_u32 v24, v25, 4, v24
    v_add_u32 v1, s86, v24
    s_mov_b32 s12, 0
    s_waitcnt lgkmcnt(0)
    s_add_u32 s10, s10, 0x9E3779B9
    s_cmp_lt_u32 s7, 15
    s_cbranch_scc1 L_NOCLR
    s_cmp_ge_u32 s6, 8
    s_cbranch_scc1 L_NOCLR
    s_sub_u32 s86, s7, 15
    s_lshl_b32 s86, s86, 12
    s_and_b32 s87, s6, 1
    s_lshl_b32 s87, s87, 11
    s_add_u32 s86, s86, s87
    s_and_b32 s87, s6, 2
    s_lshl_b32 s87, s87, 9
    s_add_u32 s86, s86, s87
    s_lshr_b32 s87, s6, 2
    s_lshl_b32 s87, s87, 9
    s_add_u32 s86, s86, s87
    s_lshl1_add_u32 s91, s86, 393216
    s_add_u32 s86, s86, 786432
    v_lshl_add_u32 v24, v0, 4, s86
    v_mov_b32 v28, -1
    v_mov_b32 v29, -1
    v_mov_b32 v30, -1
    v_mov_b32 v31, -1
    s_mov_b32 exec_hi, 0
    buffer_store_dwordx4 v[28:31], v24, s[44:47], 0 offen sc1
    s_mov_b32 exec_hi, -1
L_NOCLR:
    s_mov_b32 s83, 0
    s_waitcnt vmcnt(0)
L_SLOOP:
    s_barrier
    s_cmp_eq_u32 s83, 0
    s_cbranch_scc0 L_NOPF2
    s_mul_i32 s86, s5, 59
    s_mul_i32 s87, s77, 30
    s_add_u32 s86, s86, s87
    v_min_u32 v16, 29, v0
    v_add_u32 v16, s86, v16
    v_lshlrev_b32 v16, 7, v16
    buffer_load_dword v60, v16, s[56:59], 0 offen
    v_subrev_u32 v16, 1409024, v16
    buffer_load_dword v61, v16, s[60:63], 0 offen
L_NOPF2:
    s_cmp_eq_u32 s83, s14
    s_cbranch_scc0 L_LNOCS
    s_cmp_ge_u32 s7, 15
    s_cbranch_scc1 L_CSQ0
    ds_read_b64_tr_b16 v[24:25], v62 offset:0
    ds_read_b64_tr_b16 v[26:27], v62 offset:768
    ds_read_b64_tr_b16 v[28:29], v63 offset:0
    ds_read_b64_tr_b16 v[30:31], v63 offset:768
    ds_read_b64_tr_b16 v[32:33], v62 offset:64
    ds_read_b64_tr_b16 v[34:35], v62 offset:832
    ds_read_b64_tr_b16 v[36:37], v62 offset:12288
    ds_read_b64_tr_b16 v[38:39], v62 offset:13056
    ds_read_b64_tr_b16 v[40:41], v63 offset:12288
    ds_read_b64_tr_b16 v[42:43], v63 offset:13056
    ds_read_b64_tr_b16 v[44:45], v62 offset:12352
    ds_read_b64_tr_b16 v[46:47], v62 offset:13120
    s_branch L_CSM0
L_CSQ0:
    ds_read_b64_tr_b16 v[24:25], v62 offset:0
    ds_read_b64_tr_b16 v[26:27], v62 offset:512
    ds_read_b64_tr_b16 v[28:29], v63 offset:0
    ds_read_b64_tr_b16 v[30:31], v63 offset:512
    ds_read_b64_tr_b16 v[32:33], v62 offset:1024
    ds_read_b64_tr_b16 v[34:35], v62 offset:1536
    ds_read_b64_tr_b16 v[36:37], v63 offset:1024
    ds_read_b64_tr_b16 v[38:39], v63 offset:1536
    ds_read_b64_tr_b16 v[40:41], v62 offset:2048
    ds_read_b64_tr_b16 v[42:43], v62 offset:2560
    ds_read_b64_tr_b16 v[44:45], v63 offset:2048
    ds_read_b64_tr_b16 v[46:47], v63 offset:2560
L_CSM0:
    s_waitcnt lgkmcnt(0)
    v_mfma_f32_16x16x32_bf16 v[72:75], v[52:55], v[24:27], 0
    v_mfma_f32_16x16x32_bf16 v[76:79], v[52:55], v[28:31], 0
    v_mfma_f32_16x16x32_bf16 v[80:83], v[52:55], v[32:35], 0
    v_mfma_f32_16x16x32_bf16 v[84:87], v[52:55], v[36:39], 0
    v_mfma_f32_16x16x32_bf16 v[88:91], v[52:55], v[40:43], 0
    v_mfma_f32_16x16x32_bf16 v[92:95], v[52:55], v[44:47], 0
    s_cmp_ge_u32 s7, 15
    s_cbranch_scc1 L_CSQ1
    ds_read_b64_tr_b16 v[24:25], v62 offset:6144
    ds_read_b64_tr_b16 v[26:27], v62 offset:6912
    ds_read_b64_tr_b16 v[28:29], v63 offset:6144
    ds_read_b64_tr_b16 v[30:31], v63 offset:6912
    ds_read_b64_tr_b16 v[32:33], v62 offset:6208
    ds_read_b64_tr_b16 v[34:35], v62 offset:6976
    ds_read_b64_tr_b16 v[36:37], v62 offset:18432
    ds_read_b64_tr_b16 v[38:39], v62 offset:19200
    ds_read_b64_tr_b16 v[40:41], v63 offset:18432
    ds_read_b64_tr_b16 v[42:43], v63 offset:19200
    ds_read_b64_tr_b16 v[44:45], v62 offset:18496
    ds_read_b64_tr_b16 v[46:47], v62 offset:19264
    s_branch L_CSM1
L_CSQ1:
    ds_read_b64_tr_b16 v[24:25], v62 offset:6144
    ds_read_b64_tr_b16 v[26:27], v62 offset:6656
    ds_read_b64_tr_b16 v[28:29], v63 offset:6144
    ds_read_b64_tr_b16 v[30:31], v63 offset:6656
    ds_read_b64_tr_b16 v[32:33], v62 offset:7168
    ds_read_b64_tr_b16 v[34:35], v62 offset:7680
    ds_read_b64_tr_b16 v[36:37], v63 offset:7168
    ds_read_b64_tr_b16 v[38:39], v63 offset:7680
    ds_read_b64_tr_b16 v[40:41], v62 offset:8192
    ds_read_b64_tr_b16 v[42:43], v62 offset:8704
    ds_read_b64_tr_b16 v[44:45], v63 offset:8192
    ds_read_b64_tr_b16 v[46:47], v63 offset:8704
L_CSM1:
    s_waitcnt lgkmcnt(0)
    v_mfma_f32_16x16x32_bf16 v[72:75], v[52:55], v[24:27], v[72:75]
    v_mfma_f32_16x16x32_bf16 v[76:79], v[52:55], v[28:31], v[76:79]
    v_mfma_f32_16x16x32_bf16 v[80:83], v[52:55], v[32:35], v[80:83]
    v_mfma_f32_16x16x32_bf16 v[84:87], v[52:55], v[36:39], v[84:87]
    v_mfma_f32_16x16x32_bf16 v[88:91], v[52:55], v[40:43], v[88:91]
    v_mfma_f32_16x16x32_bf16 v[92:95], v[52:55], v[44:47], v[92:95]
    v_mov_b32 v51, s10
    s_nop 4
    v_cndmask_b32 v48, v72, v84, s[72:73]
    v_cndmask_b32 v49, v76, v88, s[72:73]
    v_cndmask_b32 v50, v80, v92, s[72:73]
    s_mov_b32 exec_hi, 0
    buffer_store_dwordx4 v[48:51], v23, s[44:47], s74 offen sc1
    s_mov_b32 exec_hi, -1
L_LNOCS:
    s_add_u32 s83, s83, 1
    s_cmp_lt_u32 s83, 6
    s_cbranch_scc1 L_SLOOP
    buffer_load_dwordx4 v[32:35], v18, s[44:47], 0 offen offset:0 sc1
    buffer_load_dwordx4 v[36:39], v18, s[44:47], 0 offen offset:1024 sc1
    buffer_load_dwordx4 v[40:43], v18, s[44:47], 0 offen offset:2048 sc1
    buffer_load_dwordx4 v[44:47], v18, s[44:47], 0 offen offset:3072 sc1
    buffer_load_dwordx4 v[48:51], v19, s[44:47], 0 offen sc1
    buffer_load_dwordx4 v[52:55], v20, s[44:47], 0 offen sc1
    s_barrier
    s_mov_b32 s86, 0
    s_mul_i32 s77, s86, 196608
    s_add_u32 s78, s77, 196608
    s_cmp_eq_u32 s78, 1376256
    s_cselect_b32 s78, 0, s78
    s_add_u32 s79, s78, 196608
    s_cmp_eq_u32 s79, 1376256
    s_cselect_b32 s79, 0, s79
    s_add_u32 s80, s79, 196608
    s_cmp_eq_u32 s80, 1376256
    s_cselect_b32 s80, 0, s80
    s_add_u32 s81, s80, 196608
    s_cmp_eq_u32 s81, 1376256
    s_cselect_b32 s81, 0, s81
    s_add_u32 s82, s81, 196608
    s_cmp_eq_u32 s82, 1376256
    s_cselect_b32 s82, 0, s82
    s_add_u32 s83, s82, 196608
    s_cmp_eq_u32 s83, 1376256
    s_cselect_b32 s83, 0, s83
    s_add_u32 m0, s76, 98304
    s_add_u32 s86, s77, 0
    s_add_u32 s87, s86, 7168
    buffer_load_dwordx4 v2, s[56:59], s86 offen lds
    buffer_load_dwordx4 v2, s[56:59], s87 offen offset:1024 lds
    s_mov_b32 s88, 0
    s_waitcnt vmcnt(2)
L_SPC:
    v_xor_b32 v24, s10, v35
    v_xor_b32 v25, s10, v39
    v_xor_b32 v26, s10, v43
    v_xor_b32 v27, s10, v47
    v_xor_b32 v28, s10, v51
    v_xor_b32 v29, s10, v55
    v_or3_b32 v24, v24, v25, v26
    v_or3_b32 v24, v24, v27, v28
    v_or_b32 v24, v24, v29
    v_cmp_ne_u32 vcc, 0, v24
    s_add_u32 s88, s88, 1
    s_cmp_gt_u32 s88, 131072
    s_cbranch_scc1 L_SPCD
    s_cbranch_vccz L_SPCD
    buffer_load_dwordx4 v[32:35], v18, s[44:47], 0 offen offset:0 sc1
    buffer_load_dwordx4 v[36:39], v18, s[44:47], 0 offen offset:1024 sc1
    buffer_load_dwordx4 v[40:43], v18, s[44:47], 0 offen offset:2048 sc1
    buffer_load_dwordx4 v[44:47], v18, s[44:47], 0 offen offset:3072 sc1
    buffer_load_dwordx4 v[48:51], v19, s[44:47], 0 offen sc1
    buffer_load_dwordx4 v[52:55], v20, s[44:47], 0 offen sc1
    s_waitcnt vmcnt(0)
    s_branch L_SPC
L_SPCD:
    s_mov_b32 s86, 147456
    s_mov_b32 s87, 150528
    v_lshl_add_u32 v24, v21, 4, s86
    v_lshl_add_u32 v25, v22, 4, s86
    v_lshl_add_u32 v21, v21, 2, s87
    v_lshl_add_u32 v22, v22, 2, s87
    ds_write_b128 v24, v[48:51]
    ds_write_b128 v25, v[52:55]
    ds_write_b32 v21, v49
    ds_write_b32 v22, v53
    v_mul_f32 v24, v48, v49
    v_mul_f32 v25, v52, v53
    ds_write_b32 v21, v24 offset:1536
    ds_write_b32 v22, v25 offset:1536
    v_add_f32 v32, v32, v36
    v_add_f32 v33, v33, v37
    v_add_f32 v34, v34, v38
    v_add_f32 v32, v32, v40
    v_add_f32 v33, v33, v41
    v_add_f32 v34, v34, v42
    v_add_f32 v32, v32, v44
    v_add_f32 v33, v33, v45
    v_add_f32 v34, v34, v46
    v_mov_b32 v36, v32
    v_mov_b32 v37, v33
    v_mov_b32 v38, v34
    v_permlane32_swap_b32 v32, v36
    v_permlane32_swap_b32 v33, v37
    v_permlane32_swap_b32 v34, v38
    v_add_f32 v32, v32, v36
    v_add_f32 v33, v33, v37
    v_add_f32 v34, v34, v38
    ds_write_b32 v17, v32 offset:0
    ds_write_b32 v17, v33 offset:64
    ds_write_b32 v17, v34 offset:128
    s_waitcnt lgkmcnt(0)
    s_barrier
L_W2:
    v_lshlrev_b32 v84, 4, v0
    v_add_u32 v84, s76, v84
    s_add_u32 m0, s76, 100352
    s_add_u32 s86, s78, 0
    s_add_u32 s87, s86, 7168
    buffer_load_dwordx4 v2, s[56:59], s86 offen lds
    buffer_load_dwordx4 v2, s[56:59], s87 offen offset:1024 lds
    s_add_u32 m0, s76, 102400
    s_add_u32 s86, s79, 0
    s_add_u32 s87, s86, 7168
    buffer_load_dwordx4 v2, s[56:59], s86 offen lds
    buffer_load_dwordx4 v2, s[56:59], s87 offen offset:1024 lds
    s_add_u32 m0, s76, 104448
    s_add_u32 s86, s80, 0
    s_add_u32 s87, s86, 7168
    buffer_load_dwordx4 v2, s[56:59], s86 offen lds
    buffer_load_dwordx4 v2, s[56:59], s87 offen offset:1024 lds
    s_add_u32 m0, s76, 106496
    s_add_u32 s86, s81, 0
    s_add_u32 s87, s86, 7168
    buffer_load_dwordx4 v2, s[56:59], s86 offen lds
    buffer_load_dwordx4 v2, s[56:59], s87 offen offset:1024 lds
    s_add_u32 m0, s76, 108544
    s_add_u32 s86, s82, 0
    s_add_u32 s87, s86, 7168
    buffer_load_dwordx4 v2, s[56:59], s86 offen lds
    buffer_load_dwordx4 v2, s[56:59], s87 offen offset:1024 lds
    s_waitcnt vmcnt(10)
    ds_read_b64_tr_b16 v[96:97], v10 offset:0
    ds_read_b64_tr_b16 v[98:99], v10 offset:512
    ds_read_b64_tr_b16 v[100:101], v11 offset:0
    ds_read_b64_tr_b16 v[102:103], v11 offset:512
    s_waitcnt lgkmcnt(0)
    s_add_u32 m0, s76, 98304
    s_add_u32 s86, s83, 0
    s_add_u32 s87, s86, 7168
    s_waitcnt vmcnt(4)
    buffer_load_dwordx4 v2, s[56:59], s86 offen lds
    s_waitcnt vmcnt(4)
    buffer_load_dwordx4 v2, s[56:59], s87 offen offset:1024 lds
    s_waitcnt vmcnt(10)
    ds_read_b64_tr_b16 v[104:105], v10 offset:2048
    ds_read_b64_tr_b16 v[106:107], v10 offset:2560
    ds_read_b64_tr_b16 v[108:109], v11 offset:2048
    ds_read_b64_tr_b16 v[110:111], v11 offset:2560
    s_waitcnt lgkmcnt(0)
    s_add_u32 m0, s76, 100352
    s_add_u32 s86, s77, 16384
    s_add_u32 s87, s86, 7168
    s_waitcnt vmcnt(4)
    buffer_load_dwordx4 v2, s[56:59], s86 offen lds
    s_waitcnt vmcnt(4)
    buffer_load_dwordx4 v2, s[56:59], s87 offen offset:1024 lds
    s_waitcnt vmcnt(10)
    ds_read_b64_tr_b16 v[112:113], v10 offset:4096
    ds_read_b64_tr_b16 v[114:115], v10 offset:4608
    ds_read_b64_tr_b16 v[116:117], v11 offset:4096
    ds_read_b64_tr_b16 v[118:119], v11 offset:4608
    s_waitcnt lgkmcnt(0)
    s_add_u32 m0, s76, 102400
    s_add_u32 s86, s78, 16384
    s_add_u32 s87, s86, 7168
    s_waitcnt vmcnt(4)
    buffer_load_dwordx4 v2, s[56:59], s86 offen lds
    s_waitcnt vmcnt(4)
    buffer_load_dwordx4 v2, s[56:59], s87 offen offset:1024 lds
    s_waitcnt vmcnt(10)
    ds_read_b64_tr_b16 v[120:121], v10 offset:6144
    ds_read_b64_tr_b16 v[122:123], v10 offset:6656
    ds_read_b64_tr_b16 v[124:125], v11 offset:6144
    ds_read_b64_tr_b16 v[126:127], v11 offset:6656
    s_waitcnt lgkmcnt(0)
    s_add_u32 m0, s76, 104448
    s_add_u32 s86, s79, 16384
    s_add_u32 s87, s86, 7168
    s_waitcnt vmcnt(4)
    buffer_load_dwordx4 v2, s[56:59], s86 offen lds
    s_waitcnt vmcnt(4)
    buffer_load_dwordx4 v2, s[56:59], s87 offen offset:1024 lds
    s_waitcnt vmcnt(10)
    ds_read_b64_tr_b16 v[128:129], v10 offset:8192
    ds_read_b64_tr_b16 v[130:131], v10 offset:8704
    ds_read_b64_tr_b16 v[132:133], v11 offset:8192
    ds_read_b64_tr_b16 v[134:135], v11 offset:8704
    s_waitcnt lgkmcnt(0)
    s_add_u32 m0, s76, 106496
    s_add_u32 s86, s80, 16384
    s_add_u32 s87, s86, 7168
    s_waitcnt vmcnt(4)
    buffer_load_dwordx4 v2, s[56:59], s86 offen lds
    s_waitcnt vmcnt(4)
    buffer_load_dwordx4 v2, s[56:59], s87 offen offset:1024 lds
    s_waitcnt vmcnt(10)
    ds_read_b64_tr_b16 v[136:137], v10 offset:10240
    ds_read_b64_tr_b16 v[138:139], v10 offset:10752
    ds_read_b64_tr_b16 v[140:141], v11 offset:10240
    ds_read_b64_tr_b16 v[142:143], v11 offset:10752
    s_waitcnt lgkmcnt(0)
    s_add_u32 m0, s76, 108544
    s_add_u32 s86, s81, 16384
    s_add_u32 s87, s86, 7168
    s_waitcnt vmcnt(4)
    buffer_load_dwordx4 v2, s[56:59], s86 offen lds
    s_waitcnt vmcnt(4)
    buffer_load_dwordx4 v2, s[56:59], s87 offen offset:1024 lds
    s_waitcnt vmcnt(10)
    ds_read_b64_tr_b16 v[144:145], v10 offset:0
    ds_read_b64_tr_b16 v[146:147], v10 offset:512
    ds_read_b64_tr_b16 v[148:149], v11 offset:0
    ds_read_b64_tr_b16 v[150:151], v11 offset:512
    s_waitcnt lgkmcnt(0)
    s_add_u32 m0, s76, 98304
    s_add_u32 s86, s82, 16384
    s_add_u32 s87, s86, 7168
    s_waitcnt vmcnt(4)
    buffer_load_dwordx4 v2, s[56:59], s86 offen lds
    s_waitcnt vmcnt(4)
    buffer_load_dwordx4 v2, s[56:59], s87 offen offset:1024 lds
    s_waitcnt vmcnt(10)
    ds_read_b64_tr_b16 v[152:153], v10 offset:2048
    ds_read_b64_tr_b16 v[154:155], v10 offset:2560
    ds_read_b64_tr_b16 v[156:157], v11 offset:2048
    ds_read_b64_tr_b16 v[158:159], v11 offset:2560
    s_waitcnt lgkmcnt(0)
    s_add_u32 m0, s76, 100352
    s_add_u32 s86, s83, 16384
    s_add_u32 s87, s86, 7168
    s_waitcnt vmcnt(4)
    buffer_load_dwordx4 v2, s[56:59], s86 offen lds
    s_waitcnt vmcnt(4)
    buffer_load_dwordx4 v2, s[56:59], s87 offen offset:1024 lds
    s_waitcnt vmcnt(10)
    ds_read_b64_tr_b16 v[160:161], v10 offset:4096
    ds_read_b64_tr_b16 v[162:163], v10 offset:4608
    ds_read_b64_tr_b16 v[164:165], v11 offset:4096
    ds_read_b64_tr_b16 v[166:167], v11 offset:4608
    s_waitcnt lgkmcnt(0)
    s_add_u32 m0, s76, 102400
    s_add_u32 s86, s77, 32768
    s_add_u32 s87, s86, 7168
    s_waitcnt vmcnt(4)
    buffer_load_dwordx4 v2, s[56:59], s86 offen lds
    s_waitcnt vmcnt(4)
    buffer_load_dwordx4 v2, s[56:59], s87 offen offset:1024 lds
    s_waitcnt vmcnt(10)
    ds_read_b64_tr_b16 v[168:169], v10 offset:6144
    ds_read_b64_tr_b16 v[170:171], v10 offset:6656
    ds_read_b64_tr_b16 v[172:173], v11 offset:6144
    ds_read_b64_tr_b16 v[174:175], v11 offset:6656
    s_waitcnt lgkmcnt(0)
    s_add_u32 m0, s76, 104448
    s_add_u32 s86, s78, 32768
    s_add_u32 s87, s86, 7168
    s_waitcnt vmcnt(4)
    buffer_load_dwordx4 v2, s[56:59], s86 offen lds
    s_waitcnt vmcnt(4)
    buffer_load_dwordx4 v2, s[56:59], s87 offen offset:1024 lds
    s_waitcnt vmcnt(10)
    ds_read_b64_tr_b16 v[176:177], v10 offset:8192
    ds_read_b64_tr_b16 v[178:179], v10 offset:8704
    ds_read_b64_tr_b16 v[180:181], v11 offset:8192
    ds_read_b64_tr_b16 v[182:183], v11 offset:8704
    s_waitcnt lgkmcnt(0)
    s_add_u32 m0, s76, 106496
    s_xor_b32 s86, s12, 98304
    s_add_u32 s87, s86, 7168
    s_waitcnt vmcnt(4)
    buffer_load_dwordx4 v4, s[60:63], s86 offen lds
    s_waitcnt vmcnt(4)
    buffer_load_dwordx4 v4, s[60:63], s87 offen offset:1024 lds
    s_waitcnt vmcnt(10)
    ds_read_b64_tr_b16 v[184:185], v10 offset:10240
    ds_read_b64_tr_b16 v[186:187], v10 offset:10752
    ds_read_b64_tr_b16 v[188:189], v11 offset:10240
    ds_read_b64_tr_b16 v[190:191], v11 offset:10752
    s_waitcnt lgkmcnt(0)
    s_add_u32 m0, s76, 108544
    s_xor_b32 s86, s12, 114688
    s_add_u32 s87, s86, 7168
    s_waitcnt vmcnt(4)
    buffer_load_dwordx4 v4, s[60:63], s86 offen lds
    s_waitcnt vmcnt(4)
    buffer_load_dwordx4 v4, s[60:63], s87 offen offset:1024 lds
    s_xor_b32 s86, s12, 0
    s_add_u32 s87, s86, 8192
    s_waitcnt vmcnt(4)
    buffer_load_dwordx4 v[192:195], v4, s[60:63], s86 offen
    s_waitcnt vmcnt(4)
    buffer_load_dwordx4 v[196:199], v4, s[60:63], s87 offen
    s_xor_b32 s86, s12, 16384
    s_add_u32 s87, s86, 8192
    s_waitcnt vmcnt(4)
    buffer_load_dwordx4 v[200:203], v4, s[60:63], s86 offen
    s_waitcnt vmcnt(4)
    buffer_load_dwordx4 v[204:207], v4, s[60:63], s87 offen
    s_xor_b32 s86, s12, 32768
    s_add_u32 s87, s86, 8192
    s_waitcnt vmcnt(4)
    buffer_load_dwordx4 v[208:211], v4, s[60:63], s86 offen
    s_waitcnt vmcnt(4)
    buffer_load_dwordx4 v[212:215], v4, s[60:63], s87 offen
    s_xor_b32 s86, s12, 49152
    s_add_u32 s87, s86, 8192
    s_waitcnt vmcnt(4)
    buffer_load_dwordx4 v[216:219], v4, s[60:63], s86 offen
    s_waitcnt vmcnt(4)
    buffer_load_dwordx4 v[220:223], v4, s[60:63], s87 offen
    s_xor_b32 s86, s12, 65536
    s_add_u32 s87, s86, 8192
    s_waitcnt vmcnt(4)
    buffer_load_dwordx4 v[224:227], v4, s[60:63], s86 offen
    s_waitcnt vmcnt(4)
    buffer_load_dwordx4 v[228:231], v4, s[60:63], s87 offen
    s_xor_b32 s86, s12, 81920
    s_add_u32 s87, s86, 8192
    s_waitcnt vmcnt(4)
    buffer_load_dwordx4 v[232:235], v4, s[60:63], s86 offen
    s_waitcnt vmcnt(4)
    buffer_load_dwordx4 v[236:239], v4, s[60:63], s87 offen
    buffer_load_dwordx4 v[12:15], v1, s[36:39], 0 offen
    v_mov_b32 v80, 152872
    s_mov_b32 s86, 0
LP_1:
    ds_read_b32 v81, v80
    s_add_u32 s86, s86, 1
    s_waitcnt lgkmcnt(0)
    v_cmp_gt_u32 vcc, 4, v81
    s_cmp_gt_u32 s86, 1048576
    s_cbranch_scc1 LPD_2
    s_cbranch_vccz LPD_2
    s_sleep 1
    s_branch LP_1
LPD_2:
    v_mov_b32 v82, s10
    s_mov_b32 s87, 0
    s_mov_b64 exec, 0x3fff
    buffer_load_dword v82, v5, s[44:47], s87 offen sc1
    s_mov_b64 exec, -1
    s_add_u32 m0, s76, 0
    s_add_u32 s86, s79, 32768
    s_add_u32 s87, s86, 7168
    s_waitcnt vmcnt(4)
    buffer_load_dwordx4 v2, s[56:59], s86 offen lds
    s_waitcnt vmcnt(4)
    buffer_load_dwordx4 v2, s[56:59], s87 offen offset:1024 lds
    s_add_u32 m0, s76, 2048
    s_add_u32 s86, s80, 32768
    s_add_u32 s87, s86, 7168
    s_waitcnt vmcnt(4)
    buffer_load_dwordx4 v2, s[56:59], s86 offen lds
    s_waitcnt vmcnt(4)
    buffer_load_dwordx4 v2, s[56:59], s87 offen offset:1024 lds
    s_add_u32 m0, s76, 4096
    s_add_u32 s86, s81, 32768
    s_add_u32 s87, s86, 7168
    s_waitcnt vmcnt(4)
    buffer_load_dwordx4 v2, s[56:59], s86 offen lds
    s_waitcnt vmcnt(4)
    buffer_load_dwordx4 v2, s[56:59], s87 offen offset:1024 lds
    s_waitcnt vmcnt(7)
    ds_write_b128 v84, v[192:195] offset:49152
    ds_write_b128 v84, v[196:199] offset:50176
    ds_write_b128 v84, v[200:203] offset:51200
    ds_write_b128 v84, v[204:207] offset:52224
    ds_write_b128 v84, v[208:211] offset:53248
    ds_write_b128 v84, v[212:215] offset:54272
    s_waitcnt vmcnt(6)
    v_cmp_ne_u32 vcc, s10, v82
    s_nop 0
    s_cbranch_vccnz L_YR0
L_YB0:
    s_lshl2_add_u32 s86, s77, 0
    buffer_load_dwordx4 v[16:19], v6, s[48:51], s86 offen sc1
    buffer_load_dwordx4 v[20:23], v6, s[48:51], s86 offen offset:1024 sc1
    s_lshl2_add_u32 s86, s78, 0
    buffer_load_dwordx4 v[24:27], v6, s[48:51], s86 offen sc1
    buffer_load_dwordx4 v[28:31], v6, s[48:51], s86 offen offset:1024 sc1
    s_lshl2_add_u32 s86, s79, 0
    buffer_load_dwordx4 v[32:35], v6, s[48:51], s86 offen sc1
    buffer_load_dwordx4 v[36:39], v6, s[48:51], s86 offen offset:1024 sc1
    s_lshl2_add_u32 s86, s80, 0
    buffer_load_dwordx4 v[40:43], v6, s[48:51], s86 offen sc1
    buffer_load_dwordx4 v[44:47], v6, s[48:51], s86 offen offset:1024 sc1
    s_lshl2_add_u32 s86, s81, 0
    buffer_load_dwordx4 v[48:51], v6, s[48:51], s86 offen sc1
    buffer_load_dwordx4 v[52:55], v6, s[48:51], s86 offen offset:1024 sc1
    ds_write_b128 v84, v[216:219] offset:55296
    ds_write_b128 v84, v[220:223] offset:56320
    ds_write_b128 v84, v[224:227] offset:57344
    ds_write_b128 v84, v[228:231] offset:58368
    ds_write_b128 v84, v[232:235] offset:59392
    ds_write_b128 v84, v[236:239] offset:60416
    s_waitcnt lgkmcnt(0)
    v_mov_b32 v80, 152864
    s_mov_b32 s86, 0
LP_3:
    ds_read_b32 v81, v80
    s_add_u32 s86, s86, 1
    s_waitcnt lgkmcnt(0)
    v_cmp_gt_u32 vcc, 4, v81
    s_cmp_gt_u32 s86, 1048576
    s_cbranch_scc1 LPD_4
    s_cbranch_vccz LPD_4
    s_sleep 1
    s_branch LP_3
LPD_4:
    s_setprio 2
    s_waitcnt vmcnt(8)
    v_mfma_f32_32x32x16_bf16 v[192:207], v[96:99], v[16:19], 0
    s_lshl2_add_u32 s86, s82, 0
    buffer_load_dwordx4 v[56:59], v6, s[48:51], s86 offen sc1
    buffer_load_dwordx4 v[60:63], v6, s[48:51], s86 offen offset:1024 sc1
    v_mfma_f32_32x32x16_bf16 v[208:223], v[100:103], v[16:19], 0
    s_add_u32 m0, s76, 6144
    s_add_u32 s86, s82, 32768
    s_add_u32 s87, s86, 7168
    buffer_load_dwordx4 v2, s[56:59], s86 offen lds
    buffer_load_dwordx4 v2, s[56:59], s87 offen offset:1024 lds
    v_mfma_f32_32x32x16_bf16 v[224:239], v[96:99], v[20:23], 0
    v_mfma_f32_32x32x16_bf16 v[240:255], v[100:103], v[20:23], 0
    s_waitcnt vmcnt(10)
    v_mfma_f32_32x32x16_bf16 v[192:207], v[104:107], v[24:27], v[192:207]
    v_mov_b32 v82, s10
    s_mov_b32 s87, 1048576
    s_mov_b64 exec, 0x3fff
    buffer_load_dword v82, v5, s[44:47], s87 offen sc1
    s_mov_b64 exec, -1
    s_lshl2_add_u32 s86, s83, 0
    buffer_load_dwordx4 v[64:67], v6, s[48:51], s86 offen sc1
    v_mfma_f32_32x32x16_bf16 v[208:223], v[108:111], v[24:27], v[208:223]
    buffer_load_dwordx4 v[68:71], v6, s[48:51], s86 offen offset:1024 sc1
    s_add_u32 m0, s76, 8192
    s_add_u32 s86, s83, 32768
    s_add_u32 s87, s86, 7168
    buffer_load_dwordx4 v2, s[56:59], s86 offen lds
    v_mfma_f32_32x32x16_bf16 v[224:239], v[104:107], v[28:31], v[224:239]
    buffer_load_dwordx4 v2, s[56:59], s87 offen offset:1024 lds
    v_mfma_f32_32x32x16_bf16 v[240:255], v[108:111], v[28:31], v[240:255]
    s_waitcnt vmcnt(4)
    v_cmp_ne_u32 vcc, s10, v82
    s_nop 0
    s_cbranch_vccnz L_YR1
L_YB1:
    v_mfma_f32_32x32x16_bf16 v[192:207], v[112:115], v[32:35], v[192:207]
    s_lshl2_add_u32 s86, s77, 65536
    buffer_load_dwordx4 v[72:75], v6, s[48:51], s86 offen sc1
    buffer_load_dwordx4 v[76:79], v6, s[48:51], s86 offen offset:1024 sc1
    v_mfma_f32_32x32x16_bf16 v[208:223], v[116:119], v[32:35], v[208:223]
    s_add_u32 m0, s76, 10240
    s_mov_b32 s86, 0
    s_add_u32 s87, s86, 7168
    buffer_load_dwordx4 v3, s[56:59], s86 offen lds
    buffer_load_dwordx4 v3, s[56:59], s87 offen offset:1024 lds
    v_mfma_f32_32x32x16_bf16 v[224:239], v[112:115], v[36:39], v[224:239]
    v_mfma_f32_32x32x16_bf16 v[240:255], v[116:119], v[36:39], v[240:255]
    s_waitcnt vmcnt(15)
    v_mfma_f32_32x32x16_bf16 v[192:207], v[120:123], v[40:43], v[192:207]
    s_lshl2_add_u32 s86, s78, 65536
    buffer_load_dwordx4 v[16:19], v6, s[48:51], s86 offen sc1
    buffer_load_dwordx4 v[20:23], v6, s[48:51], s86 offen offset:1024 sc1
    v_mfma_f32_32x32x16_bf16 v[208:223], v[124:127], v[40:43], v[208:223]
    v_mfma_f32_32x32x16_bf16 v[224:239], v[120:123], v[44:47], v[224:239]
    v_mfma_f32_32x32x16_bf16 v[240:255], v[124:127], v[44:47], v[240:255]
    s_waitcnt vmcnt(15)
    v_mfma_f32_32x32x16_bf16 v[192:207], v[128:131], v[48:51], v[192:207]
    s_lshl2_add_u32 s86, s79, 65536
    buffer_load_dwordx4 v[24:27], v6, s[48:51], s86 offen sc1
    buffer_load_dwordx4 v[28:31], v6, s[48:51], s86 offen offset:1024 sc1
    v_mfma_f32_32x32x16_bf16 v[208:223], v[132:135], v[48:51], v[208:223]
    v_mfma_f32_32x32x16_bf16 v[224:239], v[128:131], v[52:55], v[224:239]
    v_mfma_f32_32x32x16_bf16 v[240:255], v[132:135], v[52:55], v[240:255]
    s_waitcnt vmcnt(15)
    v_mfma_f32_32x32x16_bf16 v[192:207], v[136:139], v[56:59], v[192:207]
    s_lshl2_add_u32 s86, s80, 65536
    buffer_load_dwordx4 v[32:35], v6, s[48:51], s86 offen sc1
    buffer_load_dwordx4 v[36:39], v6, s[48:51], s86 offen offset:1024 sc1
    v_mfma_f32_32x32x16_bf16 v[208:223], v[140:143], v[56:59], v[208:223]
    v_mfma_f32_32x32x16_bf16 v[224:239], v[136:139], v[60:63], v[224:239]
    v_mfma_f32_32x32x16_bf16 v[240:255], v[140:143], v[60:63], v[240:255]
    s_waitcnt vmcnt(12)
    v_mfma_f32_32x32x16_bf16 v[192:207], v[144:147], v[64:67], v[192:207]
    s_lshl2_add_u32 s86, s81, 65536
    buffer_load_dwordx4 v[40:43], v6, s[48:51], s86 offen sc1
    buffer_load_dwordx4 v[44:47], v6, s[48:51], s86 offen offset:1024 sc1
    v_mfma_f32_32x32x16_bf16 v[208:223], v[148:151], v[64:67], v[208:223]
    v_mfma_f32_32x32x16_bf16 v[224:239], v[144:147], v[68:71], v[224:239]
    v_mfma_f32_32x32x16_bf16 v[240:255], v[148:151], v[68:71], v[240:255]
    s_waitcnt vmcnt(10)
    v_mfma_f32_32x32x16_bf16 v[192:207], v[152:155], v[72:75], v[192:207]
    v_mov_b32 v120, s10
    s_mov_b32 s87, 2097152
    s_mov_b64 exec, 0xffffff
    buffer_load_dword v120, v5, s[44:47], s87 offen sc1
    s_mov_b64 exec, -1
    s_lshl2_add_u32 s86, s82, 65536
    buffer_load_dwordx4 v[48:51], v6, s[48:51], s86 offen sc1
    v_mfma_f32_32x32x16_bf16 v[208:223], v[156:159], v[72:75], v[208:223]
    buffer_load_dwordx4 v[52:55], v6, s[48:51], s86 offen offset:1024 sc1
    v_mfma_f32_32x32x16_bf16 v[224:239], v[152:155], v[76:79], v[224:239]
    v_mfma_f32_32x32x16_bf16 v[240:255], v[156:159], v[76:79], v[240:255]
    s_waitcnt vmcnt(9)
    v_mfma_f32_32x32x16_bf16 v[192:207], v[160:163], v[16:19], v[192:207]
    s_lshl2_add_u32 s86, s83, 65536
    buffer_load_dwordx4 v[56:59], v6, s[48:51], s86 offen sc1
    buffer_load_dwordx4 v[60:63], v6, s[48:51], s86 offen offset:1024 sc1
    v_mfma_f32_32x32x16_bf16 v[208:223], v[164:167], v[16:19], v[208:223]
    v_mfma_f32_32x32x16_bf16 v[224:239], v[160:163], v[20:23], v[224:239]
    v_mfma_f32_32x32x16_bf16 v[240:255], v[164:167], v[20:23], v[240:255]
    s_waitcnt vmcnt(4)
    v_cmp_ne_u32 vcc, s10, v120
    s_nop 0
    s_cbranch_vccnz L_YR2
L_YB2:
    s_lshl_b32 s86, s4, 2
    s_add_u32 s86, s86, 152880
    v_mov_b32 v120, s86
    v_mov_b32 v121, 1
    ds_write_b32 v120, v121
    v_mfma_f32_32x32x16_bf16 v[192:207], v[168:171], v[24:27], v[192:207]
    s_lshl2_add_u32 s86, s77, 131072
    buffer_load_dwordx4 v[64:67], v6, s[48:51], s86 offen sc1
    buffer_load_dwordx4 v[68:71], v6, s[48:51], s86 offen offset:1024 sc1
    v_mfma_f32_32x32x16_bf16 v[208:223], v[172:175], v[24:27], v[208:223]
    v_mfma_f32_32x32x16_bf16 v[224:239], v[168:171], v[28:31], v[224:239]
    v_mfma_f32_32x32x16_bf16 v[240:255], v[172:175], v[28:31], v[240:255]
    s_waitcnt vmcnt(9)
    v_mfma_f32_32x32x16_bf16 v[192:207], v[176:179], v[32:35], v[192:207]
    s_lshl2_add_u32 s86, s78, 131072
    buffer_load_dwordx4 v[72:75], v6, s[48:51], s86 offen sc1
    buffer_load_dwordx4 v[76:79], v6, s[48:51], s86 offen offset:1024 sc1
    v_mfma_f32_32x32x16_bf16 v[208:223], v[180:183], v[32:35], v[208:223]
    v_mfma_f32_32x32x16_bf16 v[224:239], v[176:179], v[36:39], v[224:239]
    v_mfma_f32_32x32x16_bf16 v[240:255], v[180:183], v[36:39], v[240:255]
    s_waitcnt vmcnt(9)
    v_mfma_f32_32x32x16_bf16 v[192:207], v[184:187], v[40:43], v[192:207]
    s_lshl2_add_u32 s86, s79, 131072
    buffer_load_dwordx4 v[16:19], v6, s[48:51], s86 offen sc1
    buffer_load_dwordx4 v[20:23], v6, s[48:51], s86 offen offset:1024 sc1
    ds_read_b64_tr_b16 v[80:81], v10 offset:0
    ds_read_b64_tr_b16 v[82:83], v10 offset:512
    ds_read_b64_tr_b16 v[84:85], v11 offset:0
    v_mfma_f32_32x32x16_bf16 v[208:223], v[188:191], v[40:43], v[208:223]
    ds_read_b64_tr_b16 v[86:87], v11 offset:512
    v_lshrrev_b32 v96, 3, v0
    v_and_b32 v96, 4, v96
    v_xor_b32 v96, v96, v0
    v_lshlrev_b32 v96, 4, v96
    v_xor_b32 v97, 32, v96
    v_mfma_f32_32x32x16_bf16 v[224:239], v[184:187], v[44:47], v[224:239]
    v_xor_b32 v98, 0x80, v96
    v_xor_b32 v99, 0xa0, v96
    v_add_u32 v96, s76, v96
    v_add_u32 v97, s76, v97
    v_add_u32 v98, s76, v98
    v_add_u32 v99, s76, v99
    v_mfma_f32_32x32x16_bf16 v[240:255], v[188:191], v[44:47], v[240:255]
    v_add_u32 v100, 98304, v98
    v_add_u32 v101, 98304, v99
    s_and_b32 s70, s4, 2
    s_lshl_b32 s70, s70, 12
    s_add_u32 s70, s70, 0
    s_add_u32 s71, s70, 4096
    s_cmp_ge_u32 s4, 2
    s_cselect_b32 s71, 98304, s71
    v_mov_b32 v104, s70
    v_mov_b32 v105, s71
    v_and_b32 v106, 4, v0
    v_cmp_ne_u32 vcc, 0, v106
    v_and_b32 v106, 7, v0
    v_lshrrev_b32 v107, 3, v0
    v_cndmask_b32 v104, v104, v105, vcc
    v_add_u32 v107, 0, v107
    v_lshlrev_b32 v105, 1, v106
    v_xor_b32 v107, v107, v105
    s_and_b32 s70, s4, 1
    s_lshl_b32 s70, s70, 8
    v_lshl_add_u32 v104, v107, 4, v104
    v_and_b32 v105, 2, v0
    v_lshl_add_u32 v104, v105, 8, v104
    v_and_b32 v105, 1, v0
    v_lshl_add_u32 v104, v105, 11, v104
    v_add_u32 v102, s70, v104
    s_waitcnt vmcnt(8) lgkmcnt(0)
    v_mfma_f32_32x32x16_bf16 v[192:207], v[80:83], v[48:51], v[192:207]
    s_lshl2_add_u32 s86, s80, 131072
    buffer_load_dwordx4 v[24:27], v6, s[48:51], s86 offen sc1
    buffer_load_dwordx4 v[28:31], v6, s[48:51], s86 offen offset:1024 sc1
    ds_read_b64_tr_b16 v[88:89], v10 offset:2048
    ds_read_b64_tr_b16 v[90:91], v10 offset:2560
    ds_read_b64_tr_b16 v[92:93], v11 offset:2048
    v_mfma_f32_32x32x16_bf16 v[208:223], v[84:87], v[48:51], v[208:223]
    ds_read_b64_tr_b16 v[94:95], v11 offset:2560
    v_xor_b32 v103, 0x80, v102
    s_and_b32 s70, s4, 2
    s_lshl_b32 s70, s70, 12
    s_add_u32 s70, s70, 49152
    s_add_u32 s71, s70, 4096
    v_mfma_f32_32x32x16_bf16 v[224:239], v[80:83], v[52:55], v[224:239]
    s_cmp_ge_u32 s4, 2
    s_cselect_b32 s71, 106496, s71
    v_mov_b32 v104, s70
    v_mov_b32 v105, s71
    v_and_b32 v106, 4, v0
    v_cmp_ne_u32 vcc, 0, v106
    v_mfma_f32_32x32x16_bf16 v[240:255], v[84:87], v[52:55], v[240:255]
    v_and_b32 v106, 7, v0
    v_lshrrev_b32 v107, 3, v0
    v_cndmask_b32 v104, v104, v105, vcc
    v_add_u32 v107, 0, v107
    v_lshlrev_b32 v105, 1, v106
    v_xor_b32 v107, v107, v105
    s_and_b32 s70, s4, 1
    s_lshl_b32 s70, s70, 8
    v_lshl_add_u32 v104, v107, 4, v104
    v_and_b32 v105, 2, v0
    v_lshl_add_u32 v104, v105, 8, v104
    v_and_b32 v105, 1, v0
    v_lshl_add_u32 v104, v105, 11, v104
    v_add_u32 v108, s70, v104
    s_lshl_b32 s70, s4, 11
    s_add_u32 s70, s70, 153088
    v_lshl_add_u32 v109, v0, 4, s70
    v_mov_b32 v110, 152868
    v_mov_b32 v111, 1
    v_lshlrev_b32 v112, 16, v12
    v_and_b32 v113, 0xffff0000, v12
    v_lshlrev_b32 v114, 16, v13
    v_and_b32 v115, 0xffff0000, v13
    v_lshlrev_b32 v116, 16, v14
    v_and_b32 v117, 0xffff0000, v14
    v_lshlrev_b32 v118, 16, v15
    s_waitcnt vmcnt(8) lgkmcnt(0)
    v_mfma_f32_32x32x16_bf16 v[192:207], v[88:91], v[56:59], v[192:207]
    s_lshl2_add_u32 s86, s81, 131072
    buffer_load_dwordx4 v[32:35], v6, s[48:51], s86 offen sc1
    buffer_load_dwordx4 v[36:39], v6, s[48:51], s86 offen offset:1024 sc1
    v_mfma_f32_32x32x16_bf16 v[208:223], v[92:95], v[56:59], v[208:223]
    ds_read_b64_tr_b16 v[80:81], v10 offset:4096
    ds_read_b64_tr_b16 v[82:83], v10 offset:4608
    ds_read_b64_tr_b16 v[84:85], v11 offset:4096
    v_mfma_f32_32x32x16_bf16 v[224:239], v[88:91], v[60:63], v[224:239]
    ds_read_b64_tr_b16 v[86:87], v11 offset:4608
    v_and_b32 v119, 0xffff0000, v15
    s_mov_b32 s70, 0xbfb8aa3b
    v_mfma_f32_32x32x16_bf16 v[240:255], v[92:95], v[60:63], v[240:255]
    s_mov_b32 s71, s70
    s_waitcnt vmcnt(8) lgkmcnt(0)
    v_mfma_f32_32x32x16_bf16 v[192:207], v[80:83], v[64:67], v[192:207]
    s_lshl2_add_u32 s86, s82, 131072
    buffer_load_dwordx4 v[40:43], v6, s[48:51], s86 offen sc1
    buffer_load_dwordx4 v[44:47], v6, s[48:51], s86 offen offset:1024 sc1
    v_mfma_f32_32x32x16_bf16 v[208:223], v[84:87], v[64:67], v[208:223]
    ds_read_b64_tr_b16 v[88:89], v10 offset:6144
    ds_read_b64_tr_b16 v[90:91], v10 offset:6656
    ds_read_b64_tr_b16 v[92:93], v11 offset:6144
    v_mfma_f32_32x32x16_bf16 v[224:239], v[80:83], v[68:71], v[224:239]
    ds_read_b64_tr_b16 v[94:95], v11 offset:6656
    v_mfma_f32_32x32x16_bf16 v[240:255], v[84:87], v[68:71], v[240:255]
    s_waitcnt vmcnt(8) lgkmcnt(0)
    v_mfma_f32_32x32x16_bf16 v[192:207], v[88:91], v[72:75], v[192:207]
    s_lshl2_add_u32 s86, s83, 131072
    buffer_load_dwordx4 v[48:51], v6, s[48:51], s86 offen sc1
    buffer_load_dwordx4 v[52:55], v6, s[48:51], s86 offen offset:1024 sc1
    v_mfma_f32_32x32x16_bf16 v[208:223], v[92:95], v[72:75], v[208:223]
    ds_read_b64_tr_b16 v[80:81], v8 offset:0
    ds_read_b64_tr_b16 v[82:83], v8 offset:512
    ds_read_b64_tr_b16 v[84:85], v9 offset:0
    v_mfma_f32_32x32x16_bf16 v[224:239], v[88:91], v[76:79], v[224:239]
    ds_read_b64_tr_b16 v[86:87], v9 offset:512
    v_mfma_f32_32x32x16_bf16 v[240:255], v[92:95], v[76:79], v[240:255]
    s_waitcnt vmcnt(8) lgkmcnt(0)
    v_mfma_f32_32x32x16_bf16 v[192:207], v[80:83], v[16:19], v[192:207]
    s_mov_b32 s86, 0
    buffer_load_dwordx4 v[56:59], v7, s[48:51], s86 offen sc1
    buffer_load_dwordx4 v[60:63], v7, s[48:51], s86 offen offset:1024 sc1
    v_mfma_f32_32x32x16_bf16 v[208:223], v[84:87], v[16:19], v[208:223]
    ds_read_b64_tr_b16 v[88:89], v8 offset:2048
    ds_read_b64_tr_b16 v[90:91], v8 offset:2560
    ds_read_b64_tr_b16 v[92:93], v9 offset:2048
    v_mfma_f32_32x32x16_bf16 v[224:239], v[80:83], v[20:23], v[224:239]
    ds_read_b64_tr_b16 v[94:95], v9 offset:2560
    v_mfma_f32_32x32x16_bf16 v[240:255], v[84:87], v[20:23], v[240:255]
    s_waitcnt vmcnt(8) lgkmcnt(0)
    v_mfma_f32_32x32x16_bf16 v[192:207], v[88:91], v[24:27], v[192:207]
    ds_read_b64_tr_b16 v[80:81], v8 offset:4096
    ds_read_b64_tr_b16 v[82:83], v8 offset:4608
    ds_read_b64_tr_b16 v[84:85], v9 offset:4096
    v_mfma_f32_32x32x16_bf16 v[208:223], v[92:95], v[24:27], v[208:223]
    ds_read_b64_tr_b16 v[86:87], v9 offset:4608
    v_mfma_f32_32x32x16_bf16 v[224:239], v[88:91], v[28:31], v[224:239]
    v_mfma_f32_32x32x16_bf16 v[240:255], v[92:95], v[28:31], v[240:255]
    s_waitcnt vmcnt(6) lgkmcnt(0)
    v_mfma_f32_32x32x16_bf16 v[192:207], v[80:83], v[32:35], v[192:207]
    ds_read_b64_tr_b16 v[88:89], v8 offset:6144
    ds_read_b64_tr_b16 v[90:91], v8 offset:6656
    ds_read_b64_tr_b16 v[92:93], v9 offset:6144
    v_mfma_f32_32x32x16_bf16 v[208:223], v[84:87], v[32:35], v[208:223]
    ds_read_b64_tr_b16 v[94:95], v9 offset:6656
    v_mfma_f32_32x32x16_bf16 v[224:239], v[80:83], v[36:39], v[224:239]
    v_mfma_f32_32x32x16_bf16 v[240:255], v[84:87], v[36:39], v[240:255]
    s_waitcnt vmcnt(4) lgkmcnt(0)
    v_mfma_f32_32x32x16_bf16 v[192:207], v[88:91], v[40:43], v[192:207]
    ds_read_b64_tr_b16 v[80:81], v8 offset:8192
    ds_read_b64_tr_b16 v[82:83], v8 offset:8704
    ds_read_b64_tr_b16 v[84:85], v9 offset:8192
    v_mfma_f32_32x32x16_bf16 v[208:223], v[92:95], v[40:43], v[208:223]
    ds_read_b64_tr_b16 v[86:87], v9 offset:8704
    v_mfma_f32_32x32x16_bf16 v[224:239], v[88:91], v[44:47], v[224:239]
    v_mfma_f32_32x32x16_bf16 v[240:255], v[92:95], v[44:47], v[240:255]
    s_waitcnt vmcnt(2) lgkmcnt(0)
    v_mfma_f32_32x32x16_bf16 v[192:207], v[80:83], v[48:51], v[192:207]
    ds_read_b64_tr_b16 v[88:89], v8 offset:10240
    ds_read_b64_tr_b16 v[90:91], v8 offset:10752
    ds_read_b64_tr_b16 v[92:93], v9 offset:10240
    v_mfma_f32_32x32x16_bf16 v[208:223], v[84:87], v[48:51], v[208:223]
    ds_read_b64_tr_b16 v[94:95], v9 offset:10752
    v_mfma_f32_32x32x16_bf16 v[224:239], v[80:83], v[52:55], v[224:239]
    v_mfma_f32_32x32x16_bf16 v[240:255], v[84:87], v[52:55], v[240:255]
    s_waitcnt vmcnt(0) lgkmcnt(0)
    v_mfma_f32_32x32x16_bf16 v[192:207], v[88:91], v[56:59], v[192:207]
    v_mfma_f32_32x32x16_bf16 v[208:223], v[92:95], v[56:59], v[208:223]
    v_mfma_f32_32x32x16_bf16 v[224:239], v[88:91], v[60:63], v[224:239]
    v_mfma_f32_32x32x16_bf16 v[240:255], v[92:95], v[60:63], v[240:255]
    s_setprio 0
    s_nop 7
    ds_write_b128 v96, v[192:195] offset:0
    ds_write_b128 v96, v[196:199] offset:1024
    ds_write_b128 v97, v[200:203] offset:2048
    ds_write_b128 v97, v[204:207] offset:3072
    ds_write_b128 v98, v[208:211] offset:4096
    ds_write_b128 v98, v[212:215] offset:5120
    ds_write_b128 v99, v[216:219] offset:6144
    ds_write_b128 v99, v[220:223] offset:7168
    ds_write_b128 v96, v[224:227] offset:8192
    ds_write_b128 v96, v[228:231] offset:9216
    ds_write_b128 v97, v[232:235] offset:10240
    ds_write_b128 v97, v[236:239] offset:11264
    ds_write_b128 v100, v[240:243] offset:0
    ds_write_b128 v100, v[244:247] offset:1024
    ds_write_b128 v101, v[248:251] offset:2048
    ds_write_b128 v101, v[252:255] offset:3072
    v_mov_b32 v4, v108
    s_mov_b64 exec, 1
    s_waitcnt lgkmcnt(0)
    ds_add_u32 v110, v111
    s_mov_b64 exec, -1
    s_mov_b32 s86, 0
LP_5:
    ds_read_b32 v6, v110
    s_add_u32 s86, s86, 1
    s_waitcnt lgkmcnt(0)
    v_cmp_gt_u32 vcc, 4, v6
    s_cmp_gt_u32 s86, 1048576
    s_cbranch_scc1 LPD_6
    s_cbranch_vccz LPD_6
    s_sleep 1
    s_branch LP_5
LPD_6:
    ds_read_b128 v[16:19], v103 offset:0
    ds_read_b128 v[20:23], v103 offset:1024
    ds_read_b128 v[24:27], v103 offset:12288
    ds_read_b128 v[28:31], v103 offset:13312
    ds_read_b128 v[32:35], v103 offset:24576
    ds_read_b128 v[36:39], v103 offset:25600
    ds_read_b128 v[40:43], v103 offset:36864
    ds_read_b128 v[44:47], v103 offset:37888
    s_waitcnt lgkmcnt(4)
    ds_read_b128 v[48:51], v102 offset:0
    ds_read_b128 v[52:55], v102 offset:1024
    ds_read_b128 v[56:59], v102 offset:12288
    ds_read_b128 v[60:63], v102 offset:13312
    ds_read_b128 v[64:67], v102 offset:24576
    ds_read_b128 v[68:71], v102 offset:25600
    ds_read_b128 v[72:75], v102 offset:36864
    ds_read_b128 v[76:79], v102 offset:37888
    s_waitcnt lgkmcnt(8)
    v_add_f32 v16, v16, v24
    v_add_f32 v32, v32, v40
    v_add_f32 v17, v17, v25
    v_add_f32 v33, v33, v41
    v_add_f32 v18, v18, v26
    v_add_f32 v34, v34, v42
    v_add_f32 v19, v19, v27
    v_add_f32 v35, v35, v43
    v_add_f32 v20, v20, v28
    v_add_f32 v36, v36, v44
    v_add_f32 v21, v21, v29
    v_add_f32 v37, v37, v45
    v_add_f32 v22, v22, v30
    v_add_f32 v38, v38, v46
    v_add_f32 v23, v23, v31
    v_add_f32 v39, v39, v47
    v_add_f32 v16, v16, v32
    v_add_f32 v17, v17, v33
    v_add_f32 v18, v18, v34
    v_add_f32 v19, v19, v35
    v_add_f32 v20, v20, v36
    v_add_f32 v21, v21, v37
    v_add_f32 v22, v22, v38
    v_add_f32 v23, v23, v39
    v_mul_f32 v24, s70, v16
    v_mul_f32 v25, s70, v17
    v_mul_f32 v26, s70, v18
    v_mul_f32 v27, s70, v19
    v_mul_f32 v28, s70, v20
    v_mul_f32 v29, s70, v21
    v_mul_f32 v30, s70, v22
    v_mul_f32 v31, s70, v23
    v_exp_f32 v24, v24
    v_exp_f32 v25, v25
    v_exp_f32 v26, v26
    v_exp_f32 v27, v27
    v_exp_f32 v28, v28
    v_exp_f32 v29, v29
    v_exp_f32 v30, v30
    v_exp_f32 v31, v31
    v_add_f32 v24, 1.0, v24
    v_add_f32 v25, 1.0, v25
    v_add_f32 v26, 1.0, v26
    v_add_f32 v27, 1.0, v27
    v_add_f32 v28, 1.0, v28
    v_add_f32 v29, 1.0, v29
    v_add_f32 v30, 1.0, v30
    v_add_f32 v31, 1.0, v31
    v_rcp_f32 v24, v24
    v_rcp_f32 v25, v25
    v_rcp_f32 v26, v26
    v_rcp_f32 v27, v27
    v_rcp_f32 v28, v28
    v_rcp_f32 v29, v29
    v_rcp_f32 v30, v30
    v_rcp_f32 v31, v31
    v_mul_f32 v16, v16, v24
    v_mul_f32 v17, v17, v25
    v_mul_f32 v18, v18, v26
    v_mul_f32 v19, v19, v27
    v_mul_f32 v20, v20, v28
    v_mul_f32 v21, v21, v29
    v_mul_f32 v22, v22, v30
    v_mul_f32 v23, v23, v31
    ds_write_b128 v109, v[16:19]
    ds_write_b128 v109, v[20:23] offset:1024
    s_waitcnt lgkmcnt(2)
    v_add_f32 v48, v48, v56
    v_add_f32 v64, v64, v72
    v_add_f32 v49, v49, v57
    v_add_f32 v65, v65, v73
    v_add_f32 v50, v50, v58
    v_add_f32 v66, v66, v74
    v_add_f32 v51, v51, v59
    v_add_f32 v67, v67, v75
    v_add_f32 v52, v52, v60
    v_add_f32 v68, v68, v76
    v_add_f32 v53, v53, v61
    v_add_f32 v69, v69, v77
    v_add_f32 v54, v54, v62
    v_add_f32 v70, v70, v78
    v_add_f32 v55, v55, v63
    v_add_f32 v71, v71, v79
    v_add_f32 v48, v48, v64
    v_add_f32 v49, v49, v65
    v_add_f32 v50, v50, v66
    v_add_f32 v51, v51, v67
    v_add_f32 v52, v52, v68
    v_add_f32 v53, v53, v69
    v_add_f32 v54, v54, v70
    v_add_f32 v55, v55, v71
    v_mul_f32 v56, s70, v48
    v_mul_f32 v57, s70, v49
    v_mul_f32 v58, s70, v50
    v_mul_f32 v59, s70, v51
    v_mul_f32 v60, s70, v52
    v_mul_f32 v61, s70, v53
    v_mul_f32 v62, s70, v54
    v_mul_f32 v63, s70, v55
    v_exp_f32 v56, v56
    v_exp_f32 v57, v57
    v_exp_f32 v58, v58
    v_exp_f32 v59, v59
    v_exp_f32 v60, v60
    v_exp_f32 v61, v61
    v_exp_f32 v62, v62
    v_exp_f32 v63, v63
    v_add_f32 v56, 1.0, v56
    v_add_f32 v57, 1.0, v57
    v_add_f32 v58, 1.0, v58
    v_add_f32 v59, 1.0, v59
    v_add_f32 v60, 1.0, v60
    v_add_f32 v61, 1.0, v61
    v_add_f32 v62, 1.0, v62
    v_add_f32 v63, 1.0, v63
    v_rcp_f32 v56, v56
    v_rcp_f32 v57, v57
    v_rcp_f32 v58, v58
    v_rcp_f32 v59, v59
    v_rcp_f32 v60, v60
    v_rcp_f32 v61, v61
    v_rcp_f32 v62, v62
    v_rcp_f32 v63, v63
    v_mul_f32 v88, v48, v56
    v_mul_f32 v89, v49, v57
    v_mul_f32 v90, v50, v58
    v_mul_f32 v91, v51, v59
    v_mul_f32 v92, v52, v60
    v_mul_f32 v93, v53, v61
    v_mul_f32 v94, v54, v62
    v_mul_f32 v95, v55, v63
    s_waitcnt lgkmcnt(0)
    s_branch L_FINAL
L_YR0:
    s_mov_b32 s88, 1
    s_mov_b64 exec, 0x3fff
POLL_7:
    s_and_b32 s87, s88, 1
    s_lshl_b32 s87, s87, 7
    buffer_load_dword v82, v5, s[44:47], s87 offen sc1
    s_add_u32 s88, s88, 1
    s_waitcnt vmcnt(0)
    v_cmp_ne_u32 vcc, s10, v82
    s_cmp_gt_u32 s88, 131072
    s_cbranch_scc1 POLLD_8
    s_cbranch_vccz POLLD_8
    s_sleep 2
    s_branch POLL_7
POLLD_8:
    s_mov_b64 exec, -1
    s_branch L_YB0
L_YR1:
    s_mov_b32 s88, 1
    s_mov_b64 exec, 0x3fff
POLL_9:
    s_and_b32 s87, s88, 1
    s_lshl_b32 s87, s87, 7
    s_add_u32 s87, s87, 1048576
    buffer_load_dword v82, v5, s[44:47], s87 offen sc1
    s_add_u32 s88, s88, 1
    s_waitcnt vmcnt(0)
    v_cmp_ne_u32 vcc, s10, v82
    s_cmp_gt_u32 s88, 131072
    s_cbranch_scc1 POLLD_10
    s_cbranch_vccz POLLD_10
    s_sleep 2
    s_branch POLL_9
POLLD_10:
    s_mov_b64 exec, -1
    s_branch L_YB1
L_YR2:
    s_mov_b32 s88, 1
    s_mov_b64 exec, 0xffffff
POLL_11:
    s_and_b32 s87, s88, 1
    s_lshl_b32 s87, s87, 7
    s_add_u32 s87, s87, 2097152
    buffer_load_dword v120, v5, s[44:47], s87 offen sc1
    s_add_u32 s88, s88, 1
    s_waitcnt vmcnt(0)
    v_cmp_ne_u32 vcc, s10, v120
    s_cmp_gt_u32 s88, 131072
    s_cbranch_scc1 POLLD_12
    s_cbranch_vccz POLLD_12
    s_sleep 2
    s_branch POLL_11
POLLD_12:
    s_mov_b64 exec, -1
    s_branch L_YB2
L_COMPUTE:
    s_mov_b32 s44, s32
    s_mov_b32 s45, s33
    s_mov_b32 s46, 8388608
    s_mov_b32 s47, 0x20000
    s_add_u32 s48, s32, 8388608
    s_addc_u32 s49, s33, 0
    s_mov_b32 s50, 7733248
    s_mov_b32 s51, 0x20000
    s_mov_b32 s64, s30
    s_mov_b32 s65, s31
    s_mov_b32 s66, 2097152
    s_mov_b32 s67, 0x20000
    v_mov_b32 v112, 0
    v_mov_b32 v113, 0
    v_mov_b32 v114, 0
    v_mov_b32 v115, 0
    v_mov_b32 v116, 0
    v_mov_b32 v117, 0
    v_mov_b32 v118, 0
    v_mov_b32 v119, 0
    v_mov_b32 v120, 0
    v_mov_b32 v121, 0
    v_mov_b32 v122, 0
    v_mov_b32 v123, 0
    v_mov_b32 v124, 0
    v_mov_b32 v125, 0
    v_mov_b32 v126, 0
    v_mov_b32 v127, 0
    v_mov_b32 v128, 0
    v_mov_b32 v129, 0
    v_mov_b32 v130, 0
    v_mov_b32 v131, 0
    v_mov_b32 v132, 0
    v_mov_b32 v133, 0
    v_mov_b32 v134, 0
    v_mov_b32 v135, 0
    v_mov_b32 v136, 0
    v_mov_b32 v137, 0
    v_mov_b32 v138, 0
    v_mov_b32 v139, 0
    v_mov_b32 v140, 0
    v_mov_b32 v141, 0
    v_mov_b32 v142, 0
    v_mov_b32 v143, 0
    v_mov_b32 v144, 0
    v_mov_b32 v145, 0
    v_mov_b32 v146, 0
    v_mov_b32 v147, 0
    v_mov_b32 v148, 0
    v_mov_b32 v149, 0
    v_mov_b32 v150, 0
    v_mov_b32 v151, 0
    v_mov_b32 v152, 0
    v_mov_b32 v153, 0
    v_mov_b32 v154, 0
    v_mov_b32 v155, 0
    v_mov_b32 v156, 0
    v_mov_b32 v157, 0
    v_mov_b32 v158, 0
    v_mov_b32 v159, 0
    v_mov_b32 v160, 0
    v_mov_b32 v161, 0
    v_mov_b32 v162, 0
    v_mov_b32 v163, 0
    v_mov_b32 v164, 0
    v_mov_b32 v165, 0
    v_mov_b32 v166, 0
    v_mov_b32 v167, 0
    v_mov_b32 v168, 0
    v_mov_b32 v169, 0
    v_mov_b32 v170, 0
    v_mov_b32 v171, 0
    v_mov_b32 v172, 0
    v_mov_b32 v173, 0
    v_mov_b32 v174, 0
    v_mov_b32 v175, 0
    v_mov_b32 v176, 0
    v_mov_b32 v177, 0
    v_mov_b32 v178, 0
    v_mov_b32 v179, 0
    v_mov_b32 v180, 0
    v_mov_b32 v181, 0
    v_mov_b32 v182, 0
    v_mov_b32 v183, 0
    v_mov_b32 v184, 0
    v_mov_b32 v185, 0
    v_mov_b32 v186, 0
    v_mov_b32 v187, 0
    v_mov_b32 v188, 0
    v_mov_b32 v189, 0
    v_mov_b32 v190, 0
    v_mov_b32 v191, 0
    v_mov_b32 v192, 0
    v_mov_b32 v193, 0
    v_mov_b32 v194, 0
    v_mov_b32 v195, 0
    v_mov_b32 v196, 0
    v_mov_b32 v197, 0
    v_mov_b32 v198, 0
    v_mov_b32 v199, 0
    v_mov_b32 v200, 0
    v_mov_b32 v201, 0
    v_mov_b32 v202, 0
    v_mov_b32 v203, 0
    v_mov_b32 v204, 0
    v_mov_b32 v205, 0
    v_mov_b32 v206, 0
    v_mov_b32 v207, 0
    v_mov_b32 v208, 0
    v_mov_b32 v209, 0
    v_mov_b32 v210, 0
    v_mov_b32 v211, 0
    v_mov_b32 v212, 0
    v_mov_b32 v213, 0
    v_mov_b32 v214, 0
    v_mov_b32 v215, 0
    v_mov_b32 v216, 0
    v_mov_b32 v217, 0
    v_mov_b32 v218, 0
    v_mov_b32 v219, 0
    v_mov_b32 v220, 0
    v_mov_b32 v221, 0
    v_mov_b32 v222, 0
    v_mov_b32 v223, 0
    v_mov_b32 v224, 0
    v_mov_b32 v225, 0
    v_mov_b32 v226, 0
    v_mov_b32 v227, 0
    v_mov_b32 v228, 0
    v_mov_b32 v229, 0
    v_mov_b32 v230, 0
    v_mov_b32 v231, 0
    v_mov_b32 v232, 0
    v_mov_b32 v233, 0
    v_mov_b32 v234, 0
    v_mov_b32 v235, 0
    v_mov_b32 v236, 0
    v_mov_b32 v237, 0
    v_mov_b32 v238, 0
    v_mov_b32 v239, 0
    v_mov_b32 v240, 0
    v_mov_b32 v241, 0
    v_mov_b32 v242, 0
    v_mov_b32 v243, 0
    v_mov_b32 v244, 0
    v_mov_b32 v245, 0
    v_mov_b32 v246, 0
    v_mov_b32 v247, 0
    v_mov_b32 v248, 0
    v_mov_b32 v249, 0
    v_mov_b32 v250, 0
    v_mov_b32 v251, 0
    v_mov_b32 v252, 0
    v_mov_b32 v253, 0
    v_mov_b32 v254, 0
    v_mov_b32 v255, 0
    v_lshlrev_b32 v16, 2, v0
    v_add_u32 v16, 152832, v16
    v_mov_b32 v17, 0
    s_mov_b64 exec, 0xffff
    ds_write_b32 v16, v17
    s_mov_b64 exec, -1
    s_lshr_b32 s13, s4, 1
    s_and_b32 s14, s4, 1
    s_movk_i32 s11, 0x1ff
    s_lshl_b32 s86, s13, 4
    s_add_u32 s86, s86, s6
    s_cmp_eq_u32 s86, 10
    s_cselect_b32 s11, 0x1c0, s11
    s_mul_i32 s86, s14, 0x1b6
    s_cmp_eq_u32 s7, 14
    s_cselect_b32 s86, s86, 0x1ff
    s_and_b32 s11, s11, s86
    s_cmp_eq_u32 s12, 1
    s_cselect_b32 s11, 0, s11
    s_mul_i32 s76, s4, 12288
    s_lshr_b32 s86, s9, 4
    s_mul_i32 s87, s14, 3
    s_add_u32 s86, s86, s87
    s_lshl_b32 s87, s7, 1
    s_add_u32 s87, s87, s14
    s_lshl1_add_u32 s87, s87, 26
    s_and_b32 s88, s11, 0xdb
    s_cmp_ge_u32 s7, 15
    s_cselect_b32 s86, s87, s86
    s_cselect_b32 s11, s88, s11
    s_lshl_b32 s86, s86, 6
    s_lshr_b32 s87, s8, 5
    s_add_u32 s86, s86, s87
    s_mul_i32 s87, s13, 3
    s_add_u32 s86, s86, s87
    s_lshl_b32 s86, s86, 10
    v_lshl_add_u32 v1, v0, 4, s86
    s_mov_b32 s80, 0
    s_mov_b32 s81, 65536
    s_mov_b32 s82, 131072
    v_and_b32 v16, 15, v0
    v_lshrrev_b32 v17, 4, v0
    v_bfe_u32 v18, v0, 1, 3
    v_xor_b32 v18, v18, v17
    s_mul_i32 s86, s13, 12288
    v_lshl_add_u32 v16, v16, 7, s86
    v_lshl_add_u32 v2, v18, 4, v16
    v_xor_b32 v3, 64, v2
    v_and_b32 v16, 3, v0
    v_bfe_u32 v17, v0, 2, 2
    v_bfe_u32 v18, v0, 4, 1
    s_cmp_ge_u32 s7, 15
    s_cbranch_scc1 L_CAQ
    v_lshrrev_b32 v19, 4, v0
    v_lshl_add_u32 v19, v19, 3, v17
    v_mul_u32_u24 v19, 192, v19
    v_lshl_add_u32 v16, v16, 3, v19
    v_add_u32 v16, 24576, v16
    s_mul_i32 s87, s14, 3
    v_xor_b32 v19, s87, v18
    v_lshl_add_u32 v4, v19, 5, v16
    s_add_u32 s87, s87, 1
    v_xor_b32 v19, s87, v18
    v_lshl_add_u32 v5, v19, 5, v16
    s_branch L_CAD
L_CAQ:
    v_lshrrev_b32 v19, 5, v0
    v_mul_u32_u24 v19, 3072, v19
    v_lshl_add_u32 v19, v17, 7, v19
    v_mul_u32_u24 v20, 12320, v18
    v_lshrrev_b32 v17, 1, v17
    v_xor_b32 v17, s14, v17
    v_lshl_add_u32 v20, v17, 6, v20
    v_lshl_add_u32 v16, v16, 3, v19
    v_add_u32 v16, 24576, v16
    v_add_u32 v4, v16, v20
    v_xor_b32 v5, 32, v4
L_CAD:
    s_mul_i32 s86, s6, 23
    s_add_u32 s86, s86, s7
    s_cmp_eq_u32 s12, 1
    s_cselect_b32 s86, 255, s86
    s_lshl_b32 s86, s86, 2
    s_add_u32 s86, s86, s4
    s_lshl_b32 s86, s86, 10
    s_add_u32 s15, s86, 3145728
    s_waitcnt vmcnt(0)
    v_lshlrev_b32 v16, 16, v8
    v_and_b32 v17, 0xffff0000, v8
    v_lshlrev_b32 v18, 16, v9
    v_and_b32 v19, 0xffff0000, v9
    v_lshlrev_b32 v20, 16, v10
    v_and_b32 v21, 0xffff0000, v10
    v_lshlrev_b32 v22, 16, v11
    v_and_b32 v23, 0xffff0000, v11
    v_lshlrev_b32 v24, 16, v12
    v_and_b32 v25, 0xffff0000, v12
    v_lshlrev_b32 v26, 16, v13
    v_and_b32 v27, 0xffff0000, v13
    v_lshlrev_b32 v28, 16, v14
    v_and_b32 v29, 0xffff0000, v14
    v_lshlrev_b32 v30, 16, v15
    v_and_b32 v31, 0xffff0000, v15
    v_pk_add_f32 v[8:9], v[16:17], v[24:25]
    v_pk_add_f32 v[10:11], v[18:19], v[26:27]
    v_pk_add_f32 v[12:13], v[20:21], v[28:29]
    v_pk_add_f32 v[14:15], v[22:23], v[30:31]
    v_pk_add_f32 v[8:9], v[8:9], v[12:13]
    v_pk_add_f32 v[10:11], v[10:11], v[14:15]
    v_pk_add_f32 v[8:9], v[8:9], v[10:11]
    v_add_f32 v8, v8, v9
    s_nop 1
    v_add_f32_dpp v8, v8, v8 row_ror:8 row_mask:0xf bank_mask:0xf
    s_nop 1
    v_add_f32_dpp v8, v8, v8 row_ror:4 row_mask:0xf bank_mask:0xf
    s_nop 1
    v_add_f32_dpp v8, v8, v8 row_ror:2 row_mask:0xf bank_mask:0xf
    s_nop 1
    v_add_f32_dpp v8, v8, v8 row_ror:1 row_mask:0xf bank_mask:0xf
    v_mov_b32 v9, v8
    s_nop 1
    v_permlane16_swap_b32 v8, v9
    v_add_f32 v8, v8, v9
    v_mul_f32 v8, 0xbb000000, v8
    v_pk_add_f32 v[16:17], v[16:17], v[8:9] op_sel_hi:[1,0]
    v_pk_add_f32 v[18:19], v[18:19], v[8:9] op_sel_hi:[1,0]
    v_pk_add_f32 v[20:21], v[20:21], v[8:9] op_sel_hi:[1,0]
    v_pk_add_f32 v[22:23], v[22:23], v[8:9] op_sel_hi:[1,0]
    v_pk_add_f32 v[24:25], v[24:25], v[8:9] op_sel_hi:[1,0]
    v_pk_add_f32 v[26:27], v[26:27], v[8:9] op_sel_hi:[1,0]
    v_pk_add_f32 v[28:29], v[28:29], v[8:9] op_sel_hi:[1,0]
    v_pk_add_f32 v[30:31], v[30:31], v[8:9] op_sel_hi:[1,0]
    v_pk_mul_f32 v[10:11], v[16:17], v[16:17]
    v_pk_mul_f32 v[12:13], v[18:19], v[18:19]
    v_pk_fma_f32 v[10:11], v[20:21], v[20:21], v[10:11]
    v_pk_fma_f32 v[12:13], v[22:23], v[22:23], v[12:13]
    v_pk_fma_f32 v[10:11], v[24:25], v[24:25], v[10:11]
    v_pk_fma_f32 v[12:13], v[26:27], v[26:27], v[12:13]
    v_pk_fma_f32 v[10:11], v[28:29], v[28:29], v[10:11]
    v_pk_fma_f32 v[12:13], v[30:31], v[30:31], v[12:13]
    v_pk_add_f32 v[10:11], v[10:11], v[12:13]
    v_add_f32 v10, v10, v11
    s_nop 1
    v_add_f32_dpp v10, v10, v10 row_ror:8 row_mask:0xf bank_mask:0xf
    s_nop 1
    v_add_f32_dpp v10, v10, v10 row_ror:4 row_mask:0xf bank_mask:0xf
    s_nop 1
    v_add_f32_dpp v10, v10, v10 row_ror:2 row_mask:0xf bank_mask:0xf
    s_nop 1
    v_add_f32_dpp v10, v10, v10 row_ror:1 row_mask:0xf bank_mask:0xf
    v_mov_b32 v9, v10
    s_nop 1
    v_permlane16_swap_b32 v10, v9
    v_add_f32 v10, v10, v9
    v_mul_f32 v10, 0x3b000000, v10
    v_cvt_pk_bf16_f32 v10, v10, v10
    v_and_b32 v10, 0xffff0000, v10
    v_add_f32 v10, 0x3727c5ac, v10
    v_cvt_pk_bf16_f32 v10, v10, v10
    v_and_b32 v10, 0xffff0000, v10
    v_sqrt_f32 v10, v10
    v_cvt_pk_bf16_f32 v32, v8, v8
    v_cvt_pk_bf16_f32 v10, v10, v10
    v_and_b32 v10, 0xffff0000, v10
    v_and_b32 v32, 0xffff0000, v32
    v_rcp_f32 v33, v10
    v_mul_f32 v34, v10, v10
    v_lshlrev_b32 v7, 4, v7
    v_add_u32 v7, 65536, v7
    s_waitcnt lgkmcnt(0)
    s_add_u32 s10, s10, 0x9E3779B9
    v_mov_b32 v35, s10
    v_mov_b32 v36, s10
    v_mov_b32 v37, s10
    v_mov_b32 v38, s10
    v_mov_b32 v39, s10
    v_lshlrev_b32 v6, 4, v0
    s_mov_b32 s78, 0
    s_mov_b32 s79, 49152
    s_mov_b32 s83, 0
    s_barrier
    s_mov_b32 exec_lo, 1
    s_mov_b32 exec_hi, 1
    buffer_store_dwordx4 v[32:35], v7, s[44:47], 0 offen sc1
    s_mov_b64 exec, -1
    s_cmp_ge_u32 s7, 15
    s_cbranch_scc1 L_QKV
    s_or_b32 s86, s11, s12
    s_cbranch_scc0 L_DEAD
    ds_read_b128 v[40:43], v2 offset:0
    ds_read_b64_tr_b16 v[64:65], v4 offset:0
    ds_read_b64_tr_b16 v[66:67], v4 offset:768
    ds_read_b128 v[44:47], v2 offset:2048
    ds_read_b64_tr_b16 v[68:69], v5 offset:0
    ds_read_b64_tr_b16 v[70:71], v5 offset:768
    ds_read_b128 v[48:51], v2 offset:4096
    ds_read_b64_tr_b16 v[72:73], v4 offset:64
    ds_read_b64_tr_b16 v[74:75], v4 offset:832
    ds_read_b128 v[52:55], v2 offset:6144
    ds_read_b64_tr_b16 v[76:77], v4 offset:12288
    ds_read_b64_tr_b16 v[78:79], v4 offset:13056
    s_waitcnt lgkmcnt(6)
    ds_read_b128 v[56:59], v2 offset:8192
    ds_read_b64_tr_b16 v[80:81], v5 offset:12288
    ds_read_b64_tr_b16 v[82:83], v5 offset:13056
    ds_read_b128 v[60:63], v2 offset:10240
    ds_read_b64_tr_b16 v[84:85], v4 offset:12352
    ds_read_b64_tr_b16 v[86:87], v4 offset:13120
L_MLG:
    s_waitcnt lgkmcnt(0)
    v_mfma_f32_16x16x32_bf16 v[112:115], v[64:67], v[40:43], v[112:115]
    v_mfma_f32_16x16x32_bf16 v[116:119], v[68:71], v[40:43], v[116:119]
    ds_read_b128 v[8:11], v3 offset:0
    v_mfma_f32_16x16x32_bf16 v[120:123], v[72:75], v[40:43], v[120:123]
    ds_read_b64_tr_b16 v[88:89], v4 offset:6144
    v_mfma_f32_16x16x32_bf16 v[124:127], v[76:79], v[40:43], v[124:127]
    ds_read_b64_tr_b16 v[90:91], v4 offset:6912
    v_mfma_f32_16x16x32_bf16 v[128:131], v[80:83], v[40:43], v[128:131]
    ds_read_b128 v[12:15], v3 offset:2048
    v_mfma_f32_16x16x32_bf16 v[132:135], v[84:87], v[40:43], v[132:135]
    ds_read_b64_tr_b16 v[92:93], v5 offset:6144
    v_mfma_f32_16x16x32_bf16 v[136:139], v[64:67], v[44:47], v[136:139]
    v_mfma_f32_16x16x32_bf16 v[140:143], v[68:71], v[44:47], v[140:143]
    ds_read_b64_tr_b16 v[94:95], v5 offset:6912
    v_mfma_f32_16x16x32_bf16 v[144:147], v[72:75], v[44:47], v[144:147]
    ds_read_b128 v[16:19], v3 offset:4096
    v_mfma_f32_16x16x32_bf16 v[148:151], v[76:79], v[44:47], v[148:151]
    ds_read_b64_tr_b16 v[96:97], v4 offset:6208
    v_mfma_f32_16x16x32_bf16 v[152:155], v[80:83], v[44:47], v[152:155]
    ds_read_b64_tr_b16 v[98:99], v4 offset:6976
    v_mfma_f32_16x16x32_bf16 v[156:159], v[84:87], v[44:47], v[156:159]
    ds_read_b128 v[20:23], v3 offset:6144
    v_mfma_f32_16x16x32_bf16 v[160:163], v[64:67], v[48:51], v[160:163]
    v_mfma_f32_16x16x32_bf16 v[164:167], v[68:71], v[48:51], v[164:167]
    ds_read_b64_tr_b16 v[100:101], v4 offset:18432
    v_mfma_f32_16x16x32_bf16 v[168:171], v[72:75], v[48:51], v[168:171]
    ds_read_b64_tr_b16 v[102:103], v4 offset:19200
    v_mfma_f32_16x16x32_bf16 v[172:175], v[76:79], v[48:51], v[172:175]
    s_waitcnt lgkmcnt(6)
    ds_read_b128 v[24:27], v3 offset:8192
    v_mfma_f32_16x16x32_bf16 v[176:179], v[80:83], v[48:51], v[176:179]
    ds_read_b64_tr_b16 v[104:105], v5 offset:18432
    v_mfma_f32_16x16x32_bf16 v[180:183], v[84:87], v[48:51], v[180:183]
    ds_read_b64_tr_b16 v[106:107], v5 offset:19200
    v_mfma_f32_16x16x32_bf16 v[184:187], v[64:67], v[52:55], v[184:187]
    v_mfma_f32_16x16x32_bf16 v[188:191], v[68:71], v[52:55], v[188:191]
    ds_read_b128 v[28:31], v3 offset:10240
    v_mfma_f32_16x16x32_bf16 v[192:195], v[72:75], v[52:55], v[192:195]
    ds_read_b64_tr_b16 v[108:109], v4 offset:18496
    v_mfma_f32_16x16x32_bf16 v[196:199], v[76:79], v[52:55], v[196:199]
    ds_read_b64_tr_b16 v[110:111], v4 offset:19264
    v_mfma_f32_16x16x32_bf16 v[200:203], v[80:83], v[52:55], v[200:203]
    s_add_u32 s78, s78, 1
    v_mfma_f32_16x16x32_bf16 v[204:207], v[84:87], v[52:55], v[204:207]
    s_cmp_eq_u32 s78, 3
    v_mfma_f32_16x16x32_bf16 v[208:211], v[64:67], v[56:59], v[208:211]
    v_mfma_f32_16x16x32_bf16 v[212:215], v[68:71], v[56:59], v[212:215]
    s_cselect_b32 s86, 4294868992, s79
    v_mfma_f32_16x16x32_bf16 v[216:219], v[72:75], v[56:59], v[216:219]
    s_cselect_b32 s78, 0, s78
    v_mfma_f32_16x16x32_bf16 v[220:223], v[76:79], v[56:59], v[220:223]
    s_add_u32 s83, s83, 1
    v_mfma_f32_16x16x32_bf16 v[224:227], v[80:83], v[56:59], v[224:227]
    s_cmp_eq_u32 s83, 6
    v_mfma_f32_16x16x32_bf16 v[228:231], v[84:87], v[56:59], v[228:231]
    v_add_u32 v2, s86, v2
    v_mfma_f32_16x16x32_bf16 v[232:235], v[64:67], v[60:63], v[232:235]
    v_mfma_f32_16x16x32_bf16 v[236:239], v[68:71], v[60:63], v[236:239]
    v_add_u32 v4, s86, v4
    v_mfma_f32_16x16x32_bf16 v[240:243], v[72:75], v[60:63], v[240:243]
    v_add_u32 v5, s86, v5
    v_mfma_f32_16x16x32_bf16 v[244:247], v[76:79], v[60:63], v[244:247]
    v_add_u32 v3, s86, v3
    v_mfma_f32_16x16x32_bf16 v[248:251], v[80:83], v[60:63], v[248:251]
    v_mfma_f32_16x16x32_bf16 v[252:255], v[84:87], v[60:63], v[252:255]
    s_waitcnt lgkmcnt(0)
    s_barrier
    s_cbranch_scc1 L_MXG
    v_mfma_f32_16x16x32_bf16 v[112:115], v[88:91], v[8:11], v[112:115]
    v_mfma_f32_16x16x32_bf16 v[116:119], v[92:95], v[8:11], v[116:119]
    ds_read_b128 v[40:43], v2 offset:0
    v_mfma_f32_16x16x32_bf16 v[120:123], v[96:99], v[8:11], v[120:123]
    ds_read_b64_tr_b16 v[64:65], v4 offset:0
    v_mfma_f32_16x16x32_bf16 v[124:127], v[100:103], v[8:11], v[124:127]
    ds_read_b64_tr_b16 v[66:67], v4 offset:768
    v_mfma_f32_16x16x32_bf16 v[128:131], v[104:107], v[8:11], v[128:131]
    v_mfma_f32_16x16x32_bf16 v[132:135], v[108:111], v[8:11], v[132:135]
    ds_read_b128 v[44:47], v2 offset:2048
    v_mfma_f32_16x16x32_bf16 v[136:139], v[88:91], v[12:15], v[136:139]
    ds_read_b64_tr_b16 v[68:69], v5 offset:0
    v_mfma_f32_16x16x32_bf16 v[140:143], v[92:95], v[12:15], v[140:143]
    ds_read_b64_tr_b16 v[70:71], v5 offset:768
    v_mfma_f32_16x16x32_bf16 v[144:147], v[96:99], v[12:15], v[144:147]
    v_mfma_f32_16x16x32_bf16 v[148:151], v[100:103], v[12:15], v[148:151]
    ds_read_b128 v[48:51], v2 offset:4096
    v_mfma_f32_16x16x32_bf16 v[152:155], v[104:107], v[12:15], v[152:155]
    ds_read_b64_tr_b16 v[72:73], v4 offset:64
    v_mfma_f32_16x16x32_bf16 v[156:159], v[108:111], v[12:15], v[156:159]
    ds_read_b64_tr_b16 v[74:75], v4 offset:832
    v_mfma_f32_16x16x32_bf16 v[160:163], v[88:91], v[16:19], v[160:163]
    v_mfma_f32_16x16x32_bf16 v[164:167], v[92:95], v[16:19], v[164:167]
    ds_read_b128 v[52:55], v2 offset:6144
    v_mfma_f32_16x16x32_bf16 v[168:171], v[96:99], v[16:19], v[168:171]
    ds_read_b64_tr_b16 v[76:77], v4 offset:12288
    v_mfma_f32_16x16x32_bf16 v[172:175], v[100:103], v[16:19], v[172:175]
    ds_read_b64_tr_b16 v[78:79], v4 offset:13056
    v_mfma_f32_16x16x32_bf16 v[176:179], v[104:107], v[16:19], v[176:179]
    v_mfma_f32_16x16x32_bf16 v[180:183], v[108:111], v[16:19], v[180:183]
    s_waitcnt lgkmcnt(6)
    ds_read_b128 v[56:59], v2 offset:8192
    v_mfma_f32_16x16x32_bf16 v[184:187], v[88:91], v[20:23], v[184:187]
    ds_read_b64_tr_b16 v[80:81], v5 offset:12288
    v_mfma_f32_16x16x32_bf16 v[188:191], v[92:95], v[20:23], v[188:191]
    ds_read_b64_tr_b16 v[82:83], v5 offset:13056
    v_mfma_f32_16x16x32_bf16 v[192:195], v[96:99], v[20:23], v[192:195]
    v_mfma_f32_16x16x32_bf16 v[196:199], v[100:103], v[20:23], v[196:199]
    ds_read_b128 v[60:63], v2 offset:10240
    v_mfma_f32_16x16x32_bf16 v[200:203], v[104:107], v[20:23], v[200:203]
    ds_read_b64_tr_b16 v[84:85], v4 offset:12352
    v_mfma_f32_16x16x32_bf16 v[204:207], v[108:111], v[20:23], v[204:207]
    ds_read_b64_tr_b16 v[86:87], v4 offset:13120
    v_mfma_f32_16x16x32_bf16 v[208:211], v[88:91], v[24:27], v[208:211]
    v_mfma_f32_16x16x32_bf16 v[212:215], v[92:95], v[24:27], v[212:215]
    v_mfma_f32_16x16x32_bf16 v[216:219], v[96:99], v[24:27], v[216:219]
    v_mfma_f32_16x16x32_bf16 v[220:223], v[100:103], v[24:27], v[220:223]
    v_mfma_f32_16x16x32_bf16 v[224:227], v[104:107], v[24:27], v[224:227]
    v_mfma_f32_16x16x32_bf16 v[228:231], v[108:111], v[24:27], v[228:231]
    v_mfma_f32_16x16x32_bf16 v[232:235], v[88:91], v[28:31], v[232:235]
    v_mfma_f32_16x16x32_bf16 v[236:239], v[92:95], v[28:31], v[236:239]
    v_mfma_f32_16x16x32_bf16 v[240:243], v[96:99], v[28:31], v[240:243]
    v_mfma_f32_16x16x32_bf16 v[244:247], v[100:103], v[28:31], v[244:247]
    v_mfma_f32_16x16x32_bf16 v[248:251], v[104:107], v[28:31], v[248:251]
    v_mfma_f32_16x16x32_bf16 v[252:255], v[108:111], v[28:31], v[252:255]
    s_branch L_MLG
L_MXG:
    v_mfma_f32_16x16x32_bf16 v[112:115], v[88:91], v[8:11], v[112:115]
    ds_read_b64_tr_b16 v[64:65], v4 offset:0
    ds_read_b64_tr_b16 v[66:67], v4 offset:768
    v_mfma_f32_16x16x32_bf16 v[116:119], v[92:95], v[8:11], v[116:119]
    ds_read_b64_tr_b16 v[68:69], v4 offset:12288
    ds_read_b64_tr_b16 v[70:71], v4 offset:13056
    v_mfma_f32_16x16x32_bf16 v[120:123], v[96:99], v[8:11], v[120:123]
    ds_read_b128 v[40:43], v2 offset:0
    ds_read_b128 v[44:47], v2 offset:2048
    v_mfma_f32_16x16x32_bf16 v[124:127], v[100:103], v[8:11], v[124:127]
    ds_read_b128 v[48:51], v2 offset:4096
    ds_read_b128 v[52:55], v2 offset:6144
    v_mfma_f32_16x16x32_bf16 v[128:131], v[104:107], v[8:11], v[128:131]
    ds_read_b128 v[56:59], v2 offset:8192
    ds_read_b128 v[60:63], v2 offset:10240
    v_mfma_f32_16x16x32_bf16 v[132:135], v[108:111], v[8:11], v[132:135]
    s_waitcnt vmcnt(0)
    v_add_u32 v32, 49152, v4
    v_mfma_f32_16x16x32_bf16 v[136:139], v[88:91], v[12:15], v[136:139]
    v_add_u32 v33, 49152, v5
    v_and_b32 v34, 15, v0
    v_mfma_f32_16x16x32_bf16 v[140:143], v[92:95], v[12:15], v[140:143]
    s_mul_i32 s86, s13, 1536
    s_add_u32 s86, s86, 147456
    v_mfma_f32_16x16x32_bf16 v[144:147], v[96:99], v[12:15], v[144:147]
    v_lshl_add_u32 v34, v34, 4, s86
    v_lshrrev_b32 v7, 4, v0
    v_mfma_f32_16x16x32_bf16 v[148:151], v[100:103], v[12:15], v[148:151]
    s_mul_i32 s79, s14, 384
    s_add_u32 s79, s79, 151296
    v_mfma_f32_16x16x32_bf16 v[152:155], v[104:107], v[12:15], v[152:155]
    v_lshl_add_u32 v35, v7, 4, s79
    s_mul_i32 s86, s13, 384
    v_mfma_f32_16x16x32_bf16 v[156:159], v[108:111], v[12:15], v[156:159]
    s_add_u32 s86, s86, 150528
    v_lshl_add_u32 v7, v7, 4, s86
    v_mfma_f32_16x16x32_bf16 v[160:163], v[88:91], v[16:19], v[160:163]
    v_mfma_f32_16x16x32_bf16 v[164:167], v[92:95], v[16:19], v[164:167]
    v_mfma_f32_16x16x32_bf16 v[168:171], v[96:99], v[16:19], v[168:171]
    v_mfma_f32_16x16x32_bf16 v[172:175], v[100:103], v[16:19], v[172:175]
    v_mfma_f32_16x16x32_bf16 v[176:179], v[104:107], v[16:19], v[176:179]
    v_mfma_f32_16x16x32_bf16 v[180:183], v[108:111], v[16:19], v[180:183]
    v_mfma_f32_16x16x32_bf16 v[184:187], v[88:91], v[20:23], v[184:187]
    v_mfma_f32_16x16x32_bf16 v[188:191], v[92:95], v[20:23], v[188:191]
    v_mfma_f32_16x16x32_bf16 v[192:195], v[96:99], v[20:23], v[192:195]
    v_mfma_f32_16x16x32_bf16 v[196:199], v[100:103], v[20:23], v[196:199]
    v_mfma_f32_16x16x32_bf16 v[200:203], v[104:107], v[20:23], v[200:203]
    v_mfma_f32_16x16x32_bf16 v[204:207], v[108:111], v[20:23], v[204:207]
    v_mfma_f32_16x16x32_bf16 v[208:211], v[88:91], v[24:27], v[208:211]
    v_mfma_f32_16x16x32_bf16 v[212:215], v[92:95], v[24:27], v[212:215]
    v_mfma_f32_16x16x32_bf16 v[216:219], v[96:99], v[24:27], v[216:219]
    v_mfma_f32_16x16x32_bf16 v[220:223], v[100:103], v[24:27], v[220:223]
    v_mfma_f32_16x16x32_bf16 v[224:227], v[104:107], v[24:27], v[224:227]
    v_mfma_f32_16x16x32_bf16 v[228:231], v[108:111], v[24:27], v[228:231]
    v_mfma_f32_16x16x32_bf16 v[232:235], v[88:91], v[28:31], v[232:235]
    v_mfma_f32_16x16x32_bf16 v[236:239], v[92:95], v[28:31], v[236:239]
    v_mfma_f32_16x16x32_bf16 v[240:243], v[96:99], v[28:31], v[240:243]
    v_mfma_f32_16x16x32_bf16 v[244:247], v[100:103], v[28:31], v[244:247]
    v_mfma_f32_16x16x32_bf16 v[248:251], v[104:107], v[28:31], v[248:251]
    v_mfma_f32_16x16x32_bf16 v[252:255], v[108:111], v[28:31], v[252:255]
    s_waitcnt lgkmcnt(0)
    v_mfma_f32_16x16x32_bf16 v[112:115], v[64:67], v[40:43], v[112:115]
    ds_read_b64_tr_b16 v[72:73], v4 offset:6144
    v_mfma_f32_16x16x32_bf16 v[124:127], v[68:71], v[40:43], v[124:127]
    ds_read_b64_tr_b16 v[74:75], v4 offset:6912
    v_mfma_f32_16x16x32_bf16 v[136:139], v[64:67], v[44:47], v[136:139]
    ds_read_b64_tr_b16 v[76:77], v4 offset:18432
    v_mfma_f32_16x16x32_bf16 v[148:151], v[68:71], v[44:47], v[148:151]
    ds_read_b64_tr_b16 v[78:79], v4 offset:19200
    v_mfma_f32_16x16x32_bf16 v[160:163], v[64:67], v[48:51], v[160:163]
    ds_read_b128 v[8:11], v3 offset:0
    v_mfma_f32_16x16x32_bf16 v[172:175], v[68:71], v[48:51], v[172:175]
    ds_read_b128 v[12:15], v3 offset:2048
    v_mfma_f32_16x16x32_bf16 v[184:187], v[64:67], v[52:55], v[184:187]
    ds_read_b128 v[16:19], v3 offset:4096
    v_mfma_f32_16x16x32_bf16 v[196:199], v[68:71], v[52:55], v[196:199]
    ds_read_b128 v[20:23], v3 offset:6144
    v_mfma_f32_16x16x32_bf16 v[208:211], v[64:67], v[56:59], v[208:211]
    ds_read_b128 v[24:27], v3 offset:8192
    v_mfma_f32_16x16x32_bf16 v[220:223], v[68:71], v[56:59], v[220:223]
    ds_read_b128 v[28:31], v3 offset:10240
    v_mfma_f32_16x16x32_bf16 v[232:235], v[64:67], v[60:63], v[232:235]
    v_mfma_f32_16x16x32_bf16 v[244:247], v[68:71], v[60:63], v[244:247]
    s_waitcnt lgkmcnt(0)
    s_barrier
    v_mfma_f32_16x16x32_bf16 v[112:115], v[72:75], v[8:11], v[112:115]
    ds_read_b64_tr_b16 v[64:65], v32 offset:0
    ds_read_b64_tr_b16 v[66:67], v32 offset:768
    v_mfma_f32_16x16x32_bf16 v[124:127], v[76:79], v[8:11], v[124:127]
    ds_read_b64_tr_b16 v[68:69], v32 offset:12288
    ds_read_b64_tr_b16 v[70:71], v32 offset:13056
    v_mfma_f32_16x16x32_bf16 v[136:139], v[72:75], v[12:15], v[136:139]
    ds_read_b128 v[40:43], v2 offset:49152
    ds_read_b128 v[44:47], v2 offset:51200
    v_mfma_f32_16x16x32_bf16 v[148:151], v[76:79], v[12:15], v[148:151]
    ds_read_b128 v[48:51], v2 offset:53248
    ds_read_b128 v[52:55], v2 offset:55296
    v_mfma_f32_16x16x32_bf16 v[160:163], v[72:75], v[16:19], v[160:163]
    ds_read_b128 v[56:59], v2 offset:57344
    ds_read_b128 v[60:63], v2 offset:59392
    v_mfma_f32_16x16x32_bf16 v[172:175], v[76:79], v[16:19], v[172:175]
    ds_read_b128 v[88:91], v34 offset:0
    ds_read_b128 v[92:95], v34 offset:256
    v_mfma_f32_16x16x32_bf16 v[184:187], v[72:75], v[20:23], v[184:187]
    ds_read_b128 v[96:99], v34 offset:512
    ds_read_b128 v[100:103], v34 offset:768
    v_mfma_f32_16x16x32_bf16 v[196:199], v[76:79], v[20:23], v[196:199]
    v_mfma_f32_16x16x32_bf16 v[208:211], v[72:75], v[24:27], v[208:211]
    v_mfma_f32_16x16x32_bf16 v[220:223], v[76:79], v[24:27], v[220:223]
    v_mfma_f32_16x16x32_bf16 v[232:235], v[72:75], v[28:31], v[232:235]
    v_mfma_f32_16x16x32_bf16 v[244:247], v[76:79], v[28:31], v[244:247]
    s_waitcnt lgkmcnt(0)
    v_mfma_f32_16x16x32_bf16 v[112:115], v[64:67], v[40:43], v[112:115]
    ds_read_b64_tr_b16 v[72:73], v32 offset:6144
    ds_read_b64_tr_b16 v[74:75], v32 offset:6912
    v_mfma_f32_16x16x32_bf16 v[124:127], v[68:71], v[40:43], v[124:127]
    ds_read_b64_tr_b16 v[76:77], v32 offset:18432
    ds_read_b64_tr_b16 v[78:79], v32 offset:19200
    v_mfma_f32_16x16x32_bf16 v[136:139], v[64:67], v[44:47], v[136:139]
    ds_read_b128 v[8:11], v3 offset:49152
    ds_read_b128 v[12:15], v3 offset:51200
    v_mfma_f32_16x16x32_bf16 v[148:151], v[68:71], v[44:47], v[148:151]
    ds_read_b128 v[16:19], v3 offset:53248
    ds_read_b128 v[20:23], v3 offset:55296
    v_mfma_f32_16x16x32_bf16 v[160:163], v[64:67], v[48:51], v[160:163]
    ds_read_b128 v[24:27], v3 offset:57344
    ds_read_b128 v[28:31], v3 offset:59392
    v_mfma_f32_16x16x32_bf16 v[172:175], v[68:71], v[48:51], v[172:175]
    ds_read_b128 v[104:107], v34 offset:1024
    ds_read_b128 v[108:111], v34 offset:1280
    v_mfma_f32_16x16x32_bf16 v[184:187], v[64:67], v[52:55], v[184:187]
    ds_read_b128 v[80:83], v35 offset:0
    ds_read_b128 v[84:87], v35 offset:192
    v_mfma_f32_16x16x32_bf16 v[196:199], v[68:71], v[52:55], v[196:199]
    v_mfma_f32_16x16x32_bf16 v[208:211], v[64:67], v[56:59], v[208:211]
    v_mfma_f32_16x16x32_bf16 v[220:223], v[68:71], v[56:59], v[220:223]
    v_mfma_f32_16x16x32_bf16 v[232:235], v[64:67], v[60:63], v[232:235]
    v_mfma_f32_16x16x32_bf16 v[244:247], v[68:71], v[60:63], v[244:247]
    s_waitcnt lgkmcnt(0)
    v_mfma_f32_16x16x32_bf16 v[112:115], v[72:75], v[8:11], v[112:115]
    ds_read_b64_tr_b16 v[64:65], v5 offset:0
    ds_read_b64_tr_b16 v[66:67], v5 offset:768
    ds_read_b64_tr_b16 v[68:69], v5 offset:12288
    ds_read_b64_tr_b16 v[70:71], v5 offset:13056
    v_mfma_f32_16x16x32_bf16 v[124:127], v[76:79], v[8:11], v[124:127]
    ds_read_b128 v[40:43], v2 offset:0
    ds_read_b128 v[44:47], v2 offset:2048
    ds_read_b128 v[48:51], v2 offset:4096
    ds_read_b128 v[52:55], v2 offset:6144
    v_mfma_f32_16x16x32_bf16 v[136:139], v[72:75], v[12:15], v[136:139]
    ds_read_b128 v[56:59], v2 offset:8192
    ds_read_b128 v[60:63], v2 offset:10240
    v_mul_f32 v91, 0xc0135761, v89
    v_mul_f32 v89, v89, v89
    v_mfma_f32_16x16x32_bf16 v[148:151], v[76:79], v[12:15], v[148:151]
    v_mul_f32 v89, 0x3d372713, v89
    v_mul_f32 v89, v89, v91
    v_mul_f32 v95, 0xc0135761, v93
    v_mul_f32 v93, v93, v93
    v_mfma_f32_16x16x32_bf16 v[160:163], v[72:75], v[16:19], v[160:163]
    v_mul_f32 v93, 0x3d372713, v93
    v_mul_f32 v93, v93, v95
    v_mul_f32 v99, 0xc0135761, v97
    v_mul_f32 v97, v97, v97
    v_mfma_f32_16x16x32_bf16 v[172:175], v[76:79], v[16:19], v[172:175]
    v_mul_f32 v97, 0x3d372713, v97
    v_mul_f32 v97, v97, v99
    v_mul_f32 v103, 0xc0135761, v101
    v_mul_f32 v101, v101, v101
    v_mfma_f32_16x16x32_bf16 v[184:187], v[72:75], v[20:23], v[184:187]
    v_mul_f32 v101, 0x3d372713, v101
    v_mul_f32 v101, v101, v103
    v_mul_f32 v107, 0xc0135761, v105
    v_mul_f32 v105, v105, v105
    v_mfma_f32_16x16x32_bf16 v[196:199], v[76:79], v[20:23], v[196:199]
    v_mul_f32 v105, 0x3d372713, v105
    v_mul_f32 v105, v105, v107
    v_mul_f32 v111, 0xc0135761, v109
    v_mul_f32 v109, v109, v109
    v_mfma_f32_16x16x32_bf16 v[208:211], v[72:75], v[24:27], v[208:211]
    v_mul_f32 v109, 0x3d372713, v109
    v_mul_f32 v109, v109, v111
    v_mfma_f32_16x16x32_bf16 v[220:223], v[76:79], v[24:27], v[220:223]
    v_mfma_f32_16x16x32_bf16 v[232:235], v[72:75], v[28:31], v[232:235]
    v_mfma_f32_16x16x32_bf16 v[244:247], v[76:79], v[28:31], v[244:247]
    s_nop 3
    v_pk_fma_f32 v[112:113], v[80:81], v[88:89], v[112:113] op_sel_hi:[1,0,1]
    v_pk_fma_f32 v[114:115], v[82:83], v[88:89], v[114:115] op_sel_hi:[1,0,1]
    v_pk_fma_f32 v[136:137], v[80:81], v[92:93], v[136:137] op_sel_hi:[1,0,1]
    v_pk_fma_f32 v[138:139], v[82:83], v[92:93], v[138:139] op_sel_hi:[1,0,1]
    v_pk_mul_f32 v[8:9], v[112:113], v[112:113]
    v_pk_mul_f32 v[10:11], v[114:115], v[114:115]
    v_pk_mul_f32 v[12:13], v[136:137], v[136:137]
    v_pk_mul_f32 v[14:15], v[138:139], v[138:139]
    v_pk_fma_f32 v[8:9], v[8:9], v[88:89], v[90:91] op_sel:[0,1,1] op_sel_hi:[1,1,1]
    v_pk_fma_f32 v[10:11], v[10:11], v[88:89], v[90:91] op_sel:[0,1,1] op_sel_hi:[1,1,1]
    v_pk_fma_f32 v[12:13], v[12:13], v[92:93], v[94:95] op_sel:[0,1,1] op_sel_hi:[1,1,1]
    v_pk_fma_f32 v[14:15], v[14:15], v[92:93], v[94:95] op_sel:[0,1,1] op_sel_hi:[1,1,1]
    v_pk_mul_f32 v[8:9], v[8:9], v[112:113]
    v_pk_mul_f32 v[10:11], v[10:11], v[114:115]
    v_pk_mul_f32 v[12:13], v[12:13], v[136:137]
    v_pk_mul_f32 v[14:15], v[14:15], v[138:139]
    v_exp_f32 v8, v8
    v_pk_fma_f32 v[124:125], v[84:85], v[88:89], v[124:125] op_sel_hi:[1,0,1]
    v_exp_f32 v9, v9
    v_pk_fma_f32 v[126:127], v[86:87], v[88:89], v[126:127] op_sel_hi:[1,0,1]
    v_exp_f32 v10, v10
    v_pk_fma_f32 v[148:149], v[84:85], v[92:93], v[148:149] op_sel_hi:[1,0,1]
    v_exp_f32 v11, v11
    v_pk_fma_f32 v[150:151], v[86:87], v[92:93], v[150:151] op_sel_hi:[1,0,1]
    v_exp_f32 v12, v12
    v_pk_mul_f32 v[112:113], v[112:113], v[124:125]
    v_exp_f32 v13, v13
    v_pk_mul_f32 v[114:115], v[114:115], v[126:127]
    v_exp_f32 v14, v14
    v_pk_mul_f32 v[136:137], v[136:137], v[148:149]
    v_exp_f32 v15, v15
    v_pk_mul_f32 v[138:139], v[138:139], v[150:151]
    v_pk_fma_f32 v[8:9], v[8:9], v[90:91], v[90:91] op_sel_hi:[1,0,0]
    v_pk_fma_f32 v[10:11], v[10:11], v[90:91], v[90:91] op_sel_hi:[1,0,0]
    v_pk_fma_f32 v[12:13], v[12:13], v[94:95], v[94:95] op_sel_hi:[1,0,0]
    v_pk_fma_f32 v[14:15], v[14:15], v[94:95], v[94:95] op_sel_hi:[1,0,0]
    v_rcp_f32 v8, v8
    v_pk_fma_f32 v[160:161], v[80:81], v[96:97], v[160:161] op_sel_hi:[1,0,1]
    v_pk_fma_f32 v[162:163], v[82:83], v[96:97], v[162:163] op_sel_hi:[1,0,1]
    v_rcp_f32 v9, v9
    v_pk_fma_f32 v[184:185], v[80:81], v[100:101], v[184:185] op_sel_hi:[1,0,1]
    v_pk_fma_f32 v[186:187], v[82:83], v[100:101], v[186:187] op_sel_hi:[1,0,1]
    v_rcp_f32 v10, v10
    v_pk_mul_f32 v[16:17], v[160:161], v[160:161]
    v_pk_mul_f32 v[18:19], v[162:163], v[162:163]
    v_rcp_f32 v11, v11
    v_pk_mul_f32 v[20:21], v[184:185], v[184:185]
    v_pk_mul_f32 v[22:23], v[186:187], v[186:187]
    v_rcp_f32 v12, v12
    v_pk_fma_f32 v[16:17], v[16:17], v[96:97], v[98:99] op_sel:[0,1,1] op_sel_hi:[1,1,1]
    v_pk_fma_f32 v[18:19], v[18:19], v[96:97], v[98:99] op_sel:[0,1,1] op_sel_hi:[1,1,1]
    v_rcp_f32 v13, v13
    v_pk_fma_f32 v[20:21], v[20:21], v[100:101], v[102:103] op_sel:[0,1,1] op_sel_hi:[1,1,1]
    v_pk_fma_f32 v[22:23], v[22:23], v[100:101], v[102:103] op_sel:[0,1,1] op_sel_hi:[1,1,1]
    v_rcp_f32 v14, v14
    v_rcp_f32 v15, v15
    v_pk_mul_f32 v[8:9], v[8:9], v[112:113]
    v_pk_mul_f32 v[10:11], v[10:11], v[114:115]
    v_pk_mul_f32 v[12:13], v[12:13], v[136:137]
    v_pk_mul_f32 v[14:15], v[14:15], v[138:139]
    v_cvt_pk_bf16_f32 v24, v8, v9
    v_cvt_pk_bf16_f32 v26, v12, v13
    v_cvt_pk_bf16_f32 v25, v10, v11
    v_cvt_pk_bf16_f32 v27, v14, v15
    v_pk_mul_f32 v[16:17], v[16:17], v[160:161]
    v_pk_mul_f32 v[18:19], v[18:19], v[162:163]
    s_bitcmp1_b32 s11, 0
    v_permlane16_swap_b32 v24, v26
    v_permlane16_swap_b32 v25, v27
    s_cbranch_scc0 GS_13
    buffer_store_dwordx4 v[24:27], v1, s[48:51], s80 offen offset:0 sc1
GS_13:
    v_pk_mul_f32 v[20:21], v[20:21], v[184:185]
    v_pk_mul_f32 v[22:23], v[22:23], v[186:187]
    v_exp_f32 v16, v16
    v_pk_fma_f32 v[172:173], v[84:85], v[96:97], v[172:173] op_sel_hi:[1,0,1]
    v_exp_f32 v17, v17
    v_pk_fma_f32 v[174:175], v[86:87], v[96:97], v[174:175] op_sel_hi:[1,0,1]
    v_exp_f32 v18, v18
    v_pk_fma_f32 v[196:197], v[84:85], v[100:101], v[196:197] op_sel_hi:[1,0,1]
    v_exp_f32 v19, v19
    v_pk_fma_f32 v[198:199], v[86:87], v[100:101], v[198:199] op_sel_hi:[1,0,1]
    v_exp_f32 v20, v20
    v_pk_mul_f32 v[160:161], v[160:161], v[172:173]
    v_exp_f32 v21, v21
    v_pk_mul_f32 v[162:163], v[162:163], v[174:175]
    v_exp_f32 v22, v22
    v_pk_mul_f32 v[184:185], v[184:185], v[196:197]
    v_exp_f32 v23, v23
    v_pk_mul_f32 v[186:187], v[186:187], v[198:199]
    v_pk_fma_f32 v[16:17], v[16:17], v[98:99], v[98:99] op_sel_hi:[1,0,0]
    v_pk_fma_f32 v[18:19], v[18:19], v[98:99], v[98:99] op_sel_hi:[1,0,0]
    v_pk_fma_f32 v[20:21], v[20:21], v[102:103], v[102:103] op_sel_hi:[1,0,0]
    v_pk_fma_f32 v[22:23], v[22:23], v[102:103], v[102:103] op_sel_hi:[1,0,0]
    v_rcp_f32 v16, v16
    v_pk_fma_f32 v[208:209], v[80:81], v[104:105], v[208:209] op_sel_hi:[1,0,1]
    v_pk_fma_f32 v[210:211], v[82:83], v[104:105], v[210:211] op_sel_hi:[1,0,1]
    v_rcp_f32 v17, v17
    v_pk_fma_f32 v[232:233], v[80:81], v[108:109], v[232:233] op_sel_hi:[1,0,1]
    v_pk_fma_f32 v[234:235], v[82:83], v[108:109], v[234:235] op_sel_hi:[1,0,1]
    v_rcp_f32 v18, v18
    v_pk_mul_f32 v[8:9], v[208:209], v[208:209]
    v_pk_mul_f32 v[10:11], v[210:211], v[210:211]
    v_rcp_f32 v19, v19
    v_pk_mul_f32 v[12:13], v[232:233], v[232:233]
    v_pk_mul_f32 v[14:15], v[234:235], v[234:235]
    v_rcp_f32 v20, v20
    v_pk_fma_f32 v[8:9], v[8:9], v[104:105], v[106:107] op_sel:[0,1,1] op_sel_hi:[1,1,1]
    v_pk_fma_f32 v[10:11], v[10:11], v[104:105], v[106:107] op_sel:[0,1,1] op_sel_hi:[1,1,1]
    v_rcp_f32 v21, v21
    v_pk_fma_f32 v[12:13], v[12:13], v[108:109], v[110:111] op_sel:[0,1,1] op_sel_hi:[1,1,1]
    v_pk_fma_f32 v[14:15], v[14:15], v[108:109], v[110:111] op_sel:[0,1,1] op_sel_hi:[1,1,1]
    v_rcp_f32 v22, v22
    v_rcp_f32 v23, v23
    v_pk_mul_f32 v[16:17], v[16:17], v[160:161]
    v_pk_mul_f32 v[18:19], v[18:19], v[162:163]
    v_pk_mul_f32 v[20:21], v[20:21], v[184:185]
    v_pk_mul_f32 v[22:23], v[22:23], v[186:187]
    v_cvt_pk_bf16_f32 v28, v16, v17
    v_cvt_pk_bf16_f32 v30, v20, v21
    v_cvt_pk_bf16_f32 v29, v18, v19
    v_cvt_pk_bf16_f32 v31, v22, v23
    v_pk_mul_f32 v[8:9], v[8:9], v[208:209]
    v_pk_mul_f32 v[10:11], v[10:11], v[210:211]
    s_bitcmp1_b32 s11, 3
    v_permlane16_swap_b32 v28, v30
    v_permlane16_swap_b32 v29, v31
    s_cbranch_scc0 GS_14
    buffer_store_dwordx4 v[28:31], v1, s[48:51], s80 offen offset:1024 sc1
GS_14:
    v_pk_mul_f32 v[12:13], v[12:13], v[232:233]
    v_pk_mul_f32 v[14:15], v[14:15], v[234:235]
    v_exp_f32 v8, v8
    v_pk_fma_f32 v[220:221], v[84:85], v[104:105], v[220:221] op_sel_hi:[1,0,1]
    v_exp_f32 v9, v9
    v_pk_fma_f32 v[222:223], v[86:87], v[104:105], v[222:223] op_sel_hi:[1,0,1]
    v_exp_f32 v10, v10
    v_pk_fma_f32 v[244:245], v[84:85], v[108:109], v[244:245] op_sel_hi:[1,0,1]
    v_exp_f32 v11, v11
    v_pk_fma_f32 v[246:247], v[86:87], v[108:109], v[246:247] op_sel_hi:[1,0,1]
    v_exp_f32 v12, v12
    v_pk_mul_f32 v[208:209], v[208:209], v[220:221]
    v_exp_f32 v13, v13
    v_pk_mul_f32 v[210:211], v[210:211], v[222:223]
    v_exp_f32 v14, v14
    v_pk_mul_f32 v[232:233], v[232:233], v[244:245]
    v_exp_f32 v15, v15
    v_pk_mul_f32 v[234:235], v[234:235], v[246:247]
    v_pk_fma_f32 v[8:9], v[8:9], v[106:107], v[106:107] op_sel_hi:[1,0,0]
    v_pk_fma_f32 v[10:11], v[10:11], v[106:107], v[106:107] op_sel_hi:[1,0,0]
    v_pk_fma_f32 v[12:13], v[12:13], v[110:111], v[110:111] op_sel_hi:[1,0,0]
    v_pk_fma_f32 v[14:15], v[14:15], v[110:111], v[110:111] op_sel_hi:[1,0,0]
    v_rcp_f32 v8, v8
    v_rcp_f32 v9, v9
    v_rcp_f32 v10, v10
    v_rcp_f32 v11, v11
    v_rcp_f32 v12, v12
    v_rcp_f32 v13, v13
    v_rcp_f32 v14, v14
    v_rcp_f32 v15, v15
    v_pk_mul_f32 v[8:9], v[8:9], v[208:209]
    v_pk_mul_f32 v[10:11], v[10:11], v[210:211]
    v_pk_mul_f32 v[12:13], v[12:13], v[232:233]
    v_pk_mul_f32 v[14:15], v[14:15], v[234:235]
    v_cvt_pk_bf16_f32 v24, v8, v9
    v_cvt_pk_bf16_f32 v26, v12, v13
    v_cvt_pk_bf16_f32 v25, v10, v11
    v_cvt_pk_bf16_f32 v27, v14, v15
    s_bitcmp1_b32 s11, 6
    v_permlane16_swap_b32 v24, v26
    v_permlane16_swap_b32 v25, v27
    s_cbranch_scc0 GS_15
    buffer_store_dwordx4 v[24:27], v1, s[48:51], s80 offen offset:2048 sc1
GS_15:
    s_waitcnt lgkmcnt(0)
    v_mfma_f32_16x16x32_bf16 v[116:119], v[64:67], v[40:43], v[116:119]
    ds_read_b64_tr_b16 v[72:73], v5 offset:6144
    ds_read_b64_tr_b16 v[74:75], v5 offset:6912
    v_mfma_f32_16x16x32_bf16 v[128:131], v[68:71], v[40:43], v[128:131]
    ds_read_b64_tr_b16 v[76:77], v5 offset:18432
    ds_read_b64_tr_b16 v[78:79], v5 offset:19200
    v_mfma_f32_16x16x32_bf16 v[140:143], v[64:67], v[44:47], v[140:143]
    ds_read_b128 v[8:11], v3 offset:0
    ds_read_b128 v[12:15], v3 offset:2048
    v_mfma_f32_16x16x32_bf16 v[152:155], v[68:71], v[44:47], v[152:155]
    ds_read_b128 v[16:19], v3 offset:4096
    ds_read_b128 v[20:23], v3 offset:6144
    v_mfma_f32_16x16x32_bf16 v[164:167], v[64:67], v[48:51], v[164:167]
    ds_read_b128 v[24:27], v3 offset:8192
    ds_read_b128 v[28:31], v3 offset:10240
    v_mfma_f32_16x16x32_bf16 v[176:179], v[68:71], v[48:51], v[176:179]
    ds_read_b128 v[80:83], v35 offset:64
    ds_read_b128 v[84:87], v35 offset:256
    v_mfma_f32_16x16x32_bf16 v[188:191], v[64:67], v[52:55], v[188:191]
    v_mfma_f32_16x16x32_bf16 v[200:203], v[68:71], v[52:55], v[200:203]
    v_mfma_f32_16x16x32_bf16 v[212:215], v[64:67], v[56:59], v[212:215]
    v_mfma_f32_16x16x32_bf16 v[224:227], v[68:71], v[56:59], v[224:227]
    v_mfma_f32_16x16x32_bf16 v[236:239], v[64:67], v[60:63], v[236:239]
    v_mfma_f32_16x16x32_bf16 v[248:251], v[68:71], v[60:63], v[248:251]
    s_waitcnt lgkmcnt(0)
    v_mfma_f32_16x16x32_bf16 v[116:119], v[72:75], v[8:11], v[116:119]
    ds_read_b64_tr_b16 v[64:65], v33 offset:0
    v_mfma_f32_16x16x32_bf16 v[128:131], v[76:79], v[8:11], v[128:131]
    ds_read_b64_tr_b16 v[66:67], v33 offset:768
    v_mfma_f32_16x16x32_bf16 v[140:143], v[72:75], v[12:15], v[140:143]
    ds_read_b64_tr_b16 v[68:69], v33 offset:12288
    v_mfma_f32_16x16x32_bf16 v[152:155], v[76:79], v[12:15], v[152:155]
    ds_read_b64_tr_b16 v[70:71], v33 offset:13056
    v_mfma_f32_16x16x32_bf16 v[164:167], v[72:75], v[16:19], v[164:167]
    ds_read_b128 v[40:43], v2 offset:49152
    v_mfma_f32_16x16x32_bf16 v[176:179], v[76:79], v[16:19], v[176:179]
    ds_read_b128 v[44:47], v2 offset:51200
    v_mfma_f32_16x16x32_bf16 v[188:191], v[72:75], v[20:23], v[188:191]
    ds_read_b128 v[48:51], v2 offset:53248
    v_mfma_f32_16x16x32_bf16 v[200:203], v[76:79], v[20:23], v[200:203]
    ds_read_b128 v[52:55], v2 offset:55296
    v_mfma_f32_16x16x32_bf16 v[212:215], v[72:75], v[24:27], v[212:215]
    ds_read_b128 v[56:59], v2 offset:57344
    v_mfma_f32_16x16x32_bf16 v[224:227], v[76:79], v[24:27], v[224:227]
    ds_read_b128 v[60:63], v2 offset:59392
    v_mfma_f32_16x16x32_bf16 v[236:239], v[72:75], v[28:31], v[236:239]
    v_mfma_f32_16x16x32_bf16 v[248:251], v[76:79], v[28:31], v[248:251]
    s_waitcnt lgkmcnt(0)
    v_mfma_f32_16x16x32_bf16 v[116:119], v[64:67], v[40:43], v[116:119]
    ds_read_b64_tr_b16 v[72:73], v33 offset:6144
    v_mfma_f32_16x16x32_bf16 v[128:131], v[68:71], v[40:43], v[128:131]
    ds_read_b64_tr_b16 v[74:75], v33 offset:6912
    v_mfma_f32_16x16x32_bf16 v[140:143], v[64:67], v[44:47], v[140:143]
    ds_read_b64_tr_b16 v[76:77], v33 offset:18432
    v_mfma_f32_16x16x32_bf16 v[152:155], v[68:71], v[44:47], v[152:155]
    ds_read_b64_tr_b16 v[78:79], v33 offset:19200
    v_mfma_f32_16x16x32_bf16 v[164:167], v[64:67], v[48:51], v[164:167]
    ds_read_b128 v[8:11], v3 offset:49152
    v_mfma_f32_16x16x32_bf16 v[176:179], v[68:71], v[48:51], v[176:179]
    ds_read_b128 v[12:15], v3 offset:51200
    v_mfma_f32_16x16x32_bf16 v[188:191], v[64:67], v[52:55], v[188:191]
    ds_read_b128 v[16:19], v3 offset:53248
    v_mfma_f32_16x16x32_bf16 v[200:203], v[68:71], v[52:55], v[200:203]
    ds_read_b128 v[20:23], v3 offset:55296
    v_mfma_f32_16x16x32_bf16 v[212:215], v[64:67], v[56:59], v[212:215]
    ds_read_b128 v[24:27], v3 offset:57344
    v_mfma_f32_16x16x32_bf16 v[224:227], v[68:71], v[56:59], v[224:227]
    ds_read_b128 v[28:31], v3 offset:59392
    v_mfma_f32_16x16x32_bf16 v[236:239], v[64:67], v[60:63], v[236:239]
    v_mfma_f32_16x16x32_bf16 v[248:251], v[68:71], v[60:63], v[248:251]
    s_waitcnt lgkmcnt(0)
    v_mfma_f32_16x16x32_bf16 v[116:119], v[72:75], v[8:11], v[116:119]
    ds_read_b64_tr_b16 v[64:65], v4 offset:64
    v_mfma_f32_16x16x32_bf16 v[128:131], v[76:79], v[8:11], v[128:131]
    ds_read_b64_tr_b16 v[66:67], v4 offset:832
    v_mfma_f32_16x16x32_bf16 v[140:143], v[72:75], v[12:15], v[140:143]
    ds_read_b64_tr_b16 v[68:69], v4 offset:12352
    v_mfma_f32_16x16x32_bf16 v[152:155], v[76:79], v[12:15], v[152:155]
    ds_read_b64_tr_b16 v[70:71], v4 offset:13120
    v_mfma_f32_16x16x32_bf16 v[164:167], v[72:75], v[16:19], v[164:167]
    ds_read_b128 v[40:43], v2 offset:0
    v_mfma_f32_16x16x32_bf16 v[176:179], v[76:79], v[16:19], v[176:179]
    ds_read_b128 v[44:47], v2 offset:2048
    v_mfma_f32_16x16x32_bf16 v[188:191], v[72:75], v[20:23], v[188:191]
    ds_read_b128 v[48:51], v2 offset:4096
    v_mfma_f32_16x16x32_bf16 v[200:203], v[76:79], v[20:23], v[200:203]
    ds_read_b128 v[52:55], v2 offset:6144
    v_mfma_f32_16x16x32_bf16 v[212:215], v[72:75], v[24:27], v[212:215]
    ds_read_b128 v[56:59], v2 offset:8192
    v_mfma_f32_16x16x32_bf16 v[224:227], v[76:79], v[24:27], v[224:227]
    ds_read_b128 v[60:63], v2 offset:10240
    v_mfma_f32_16x16x32_bf16 v[236:239], v[72:75], v[28:31], v[236:239]
    v_mfma_f32_16x16x32_bf16 v[248:251], v[76:79], v[28:31], v[248:251]
    s_waitcnt vmcnt(0)
    s_add_u32 s86, s15, 0
    s_mov_b64 exec, 0xffff
    buffer_store_dwordx4 v[36:39], v6, s[44:47], s86 offen sc1
    s_mov_b64 exec, -1
    v_pk_fma_f32 v[116:117], v[80:81], v[88:89], v[116:117] op_sel_hi:[1,0,1]
    v_pk_fma_f32 v[118:119], v[82:83], v[88:89], v[118:119] op_sel_hi:[1,0,1]
    v_pk_fma_f32 v[140:141], v[80:81], v[92:93], v[140:141] op_sel_hi:[1,0,1]
    v_pk_fma_f32 v[142:143], v[82:83], v[92:93], v[142:143] op_sel_hi:[1,0,1]
    v_pk_mul_f32 v[8:9], v[116:117], v[116:117]
    v_pk_mul_f32 v[10:11], v[118:119], v[118:119]
    v_pk_mul_f32 v[12:13], v[140:141], v[140:141]
    v_pk_mul_f32 v[14:15], v[142:143], v[142:143]
    v_pk_fma_f32 v[8:9], v[8:9], v[88:89], v[90:91] op_sel:[0,1,1] op_sel_hi:[1,1,1]
    v_pk_fma_f32 v[10:11], v[10:11], v[88:89], v[90:91] op_sel:[0,1,1] op_sel_hi:[1,1,1]
    v_pk_fma_f32 v[12:13], v[12:13], v[92:93], v[94:95] op_sel:[0,1,1] op_sel_hi:[1,1,1]
    v_pk_fma_f32 v[14:15], v[14:15], v[92:93], v[94:95] op_sel:[0,1,1] op_sel_hi:[1,1,1]
    v_pk_mul_f32 v[8:9], v[8:9], v[116:117]
    v_pk_mul_f32 v[10:11], v[10:11], v[118:119]
    v_pk_mul_f32 v[12:13], v[12:13], v[140:141]
    v_pk_mul_f32 v[14:15], v[14:15], v[142:143]
    v_exp_f32 v8, v8
    v_pk_fma_f32 v[128:129], v[84:85], v[88:89], v[128:129] op_sel_hi:[1,0,1]
    v_exp_f32 v9, v9
    v_pk_fma_f32 v[130:131], v[86:87], v[88:89], v[130:131] op_sel_hi:[1,0,1]
    v_exp_f32 v10, v10
    v_pk_fma_f32 v[152:153], v[84:85], v[92:93], v[152:153] op_sel_hi:[1,0,1]
    v_exp_f32 v11, v11
    v_pk_fma_f32 v[154:155], v[86:87], v[92:93], v[154:155] op_sel_hi:[1,0,1]
    v_exp_f32 v12, v12
    v_pk_mul_f32 v[116:117], v[116:117], v[128:129]
    v_exp_f32 v13, v13
    v_pk_mul_f32 v[118:119], v[118:119], v[130:131]
    v_exp_f32 v14, v14
    v_pk_mul_f32 v[140:141], v[140:141], v[152:153]
    v_exp_f32 v15, v15
    v_pk_mul_f32 v[142:143], v[142:143], v[154:155]
    v_pk_fma_f32 v[8:9], v[8:9], v[90:91], v[90:91] op_sel_hi:[1,0,0]
    v_pk_fma_f32 v[10:11], v[10:11], v[90:91], v[90:91] op_sel_hi:[1,0,0]
    v_pk_fma_f32 v[12:13], v[12:13], v[94:95], v[94:95] op_sel_hi:[1,0,0]
    v_pk_fma_f32 v[14:15], v[14:15], v[94:95], v[94:95] op_sel_hi:[1,0,0]
    v_rcp_f32 v8, v8
    v_pk_fma_f32 v[164:165], v[80:81], v[96:97], v[164:165] op_sel_hi:[1,0,1]
    v_pk_fma_f32 v[166:167], v[82:83], v[96:97], v[166:167] op_sel_hi:[1,0,1]
    v_rcp_f32 v9, v9
    v_pk_fma_f32 v[188:189], v[80:81], v[100:101], v[188:189] op_sel_hi:[1,0,1]
    v_pk_fma_f32 v[190:191], v[82:83], v[100:101], v[190:191] op_sel_hi:[1,0,1]
    v_rcp_f32 v10, v10
    v_pk_mul_f32 v[16:17], v[164:165], v[164:165]
    v_pk_mul_f32 v[18:19], v[166:167], v[166:167]
    v_rcp_f32 v11, v11
    v_pk_mul_f32 v[20:21], v[188:189], v[188:189]
    v_pk_mul_f32 v[22:23], v[190:191], v[190:191]
    v_rcp_f32 v12, v12
    v_pk_fma_f32 v[16:17], v[16:17], v[96:97], v[98:99] op_sel:[0,1,1] op_sel_hi:[1,1,1]
    v_pk_fma_f32 v[18:19], v[18:19], v[96:97], v[98:99] op_sel:[0,1,1] op_sel_hi:[1,1,1]
    v_rcp_f32 v13, v13
    v_pk_fma_f32 v[20:21], v[20:21], v[100:101], v[102:103] op_sel:[0,1,1] op_sel_hi:[1,1,1]
    v_pk_fma_f32 v[22:23], v[22:23], v[100:101], v[102:103] op_sel:[0,1,1] op_sel_hi:[1,1,1]
    v_rcp_f32 v14, v14
    v_rcp_f32 v15, v15
    v_pk_mul_f32 v[8:9], v[8:9], v[116:117]
    v_pk_mul_f32 v[10:11], v[10:11], v[118:119]
    v_pk_mul_f32 v[12:13], v[12:13], v[140:141]
    v_pk_mul_f32 v[14:15], v[14:15], v[142:143]
    v_cvt_pk_bf16_f32 v24, v8, v9
    v_cvt_pk_bf16_f32 v26, v12, v13
    v_cvt_pk_bf16_f32 v25, v10, v11
    v_cvt_pk_bf16_f32 v27, v14, v15
    v_pk_mul_f32 v[16:17], v[16:17], v[164:165]
    v_pk_mul_f32 v[18:19], v[18:19], v[166:167]
    s_bitcmp1_b32 s11, 1
    v_permlane16_swap_b32 v24, v26
    v_permlane16_swap_b32 v25, v27
    s_cbranch_scc0 GS_16
    buffer_store_dwordx4 v[24:27], v1, s[48:51], s81 offen offset:0 sc1
GS_16:
    v_pk_mul_f32 v[20:21], v[20:21], v[188:189]
    v_pk_mul_f32 v[22:23], v[22:23], v[190:191]
    v_exp_f32 v16, v16
    v_pk_fma_f32 v[176:177], v[84:85], v[96:97], v[176:177] op_sel_hi:[1,0,1]
    v_exp_f32 v17, v17
    v_pk_fma_f32 v[178:179], v[86:87], v[96:97], v[178:179] op_sel_hi:[1,0,1]
    v_exp_f32 v18, v18
    v_pk_fma_f32 v[200:201], v[84:85], v[100:101], v[200:201] op_sel_hi:[1,0,1]
    v_exp_f32 v19, v19
    v_pk_fma_f32 v[202:203], v[86:87], v[100:101], v[202:203] op_sel_hi:[1,0,1]
    v_exp_f32 v20, v20
    v_pk_mul_f32 v[164:165], v[164:165], v[176:177]
    v_exp_f32 v21, v21
    v_pk_mul_f32 v[166:167], v[166:167], v[178:179]
    v_exp_f32 v22, v22
    v_pk_mul_f32 v[188:189], v[188:189], v[200:201]
    v_exp_f32 v23, v23
    v_pk_mul_f32 v[190:191], v[190:191], v[202:203]
    v_pk_fma_f32 v[16:17], v[16:17], v[98:99], v[98:99] op_sel_hi:[1,0,0]
    v_pk_fma_f32 v[18:19], v[18:19], v[98:99], v[98:99] op_sel_hi:[1,0,0]
    v_pk_fma_f32 v[20:21], v[20:21], v[102:103], v[102:103] op_sel_hi:[1,0,0]
    v_pk_fma_f32 v[22:23], v[22:23], v[102:103], v[102:103] op_sel_hi:[1,0,0]
    v_rcp_f32 v16, v16
    v_pk_fma_f32 v[212:213], v[80:81], v[104:105], v[212:213] op_sel_hi:[1,0,1]
    v_pk_fma_f32 v[214:215], v[82:83], v[104:105], v[214:215] op_sel_hi:[1,0,1]
    v_rcp_f32 v17, v17
    v_pk_fma_f32 v[236:237], v[80:81], v[108:109], v[236:237] op_sel_hi:[1,0,1]
    v_pk_fma_f32 v[238:239], v[82:83], v[108:109], v[238:239] op_sel_hi:[1,0,1]
    v_rcp_f32 v18, v18
    v_pk_mul_f32 v[8:9], v[212:213], v[212:213]
    v_pk_mul_f32 v[10:11], v[214:215], v[214:215]
    v_rcp_f32 v19, v19
    v_pk_mul_f32 v[12:13], v[236:237], v[236:237]
    v_pk_mul_f32 v[14:15], v[238:239], v[238:239]
    v_rcp_f32 v20, v20
    v_pk_fma_f32 v[8:9], v[8:9], v[104:105], v[106:107] op_sel:[0,1,1] op_sel_hi:[1,1,1]
    v_pk_fma_f32 v[10:11], v[10:11], v[104:105], v[106:107] op_sel:[0,1,1] op_sel_hi:[1,1,1]
    v_rcp_f32 v21, v21
    v_pk_fma_f32 v[12:13], v[12:13], v[108:109], v[110:111] op_sel:[0,1,1] op_sel_hi:[1,1,1]
    v_pk_fma_f32 v[14:15], v[14:15], v[108:109], v[110:111] op_sel:[0,1,1] op_sel_hi:[1,1,1]
    v_rcp_f32 v22, v22
    v_rcp_f32 v23, v23
    v_pk_mul_f32 v[16:17], v[16:17], v[164:165]
    v_pk_mul_f32 v[18:19], v[18:19], v[166:167]
    v_pk_mul_f32 v[20:21], v[20:21], v[188:189]
    v_pk_mul_f32 v[22:23], v[22:23], v[190:191]
    v_cvt_pk_bf16_f32 v28, v16, v17
    v_cvt_pk_bf16_f32 v30, v20, v21
    v_cvt_pk_bf16_f32 v29, v18, v19
    v_cvt_pk_bf16_f32 v31, v22, v23
    v_pk_mul_f32 v[8:9], v[8:9], v[212:213]
    v_pk_mul_f32 v[10:11], v[10:11], v[214:215]
    s_bitcmp1_b32 s11, 4
    v_permlane16_swap_b32 v28, v30
    v_permlane16_swap_b32 v29, v31
    s_cbranch_scc0 GS_17
    buffer_store_dwordx4 v[28:31], v1, s[48:51], s81 offen offset:1024 sc1
GS_17:
    v_pk_mul_f32 v[12:13], v[12:13], v[236:237]
    v_pk_mul_f32 v[14:15], v[14:15], v[238:239]
    v_exp_f32 v8, v8
    v_pk_fma_f32 v[224:225], v[84:85], v[104:105], v[224:225] op_sel_hi:[1,0,1]
    v_exp_f32 v9, v9
    v_pk_fma_f32 v[226:227], v[86:87], v[104:105], v[226:227] op_sel_hi:[1,0,1]
    v_exp_f32 v10, v10
    v_pk_fma_f32 v[248:249], v[84:85], v[108:109], v[248:249] op_sel_hi:[1,0,1]
    v_exp_f32 v11, v11
    v_pk_fma_f32 v[250:251], v[86:87], v[108:109], v[250:251] op_sel_hi:[1,0,1]
    v_exp_f32 v12, v12
    v_pk_mul_f32 v[212:213], v[212:213], v[224:225]
    v_exp_f32 v13, v13
    v_pk_mul_f32 v[214:215], v[214:215], v[226:227]
    v_exp_f32 v14, v14
    v_pk_mul_f32 v[236:237], v[236:237], v[248:249]
    v_exp_f32 v15, v15
    v_pk_mul_f32 v[238:239], v[238:239], v[250:251]
    v_pk_fma_f32 v[8:9], v[8:9], v[106:107], v[106:107] op_sel_hi:[1,0,0]
    v_pk_fma_f32 v[10:11], v[10:11], v[106:107], v[106:107] op_sel_hi:[1,0,0]
    v_pk_fma_f32 v[12:13], v[12:13], v[110:111], v[110:111] op_sel_hi:[1,0,0]
    v_pk_fma_f32 v[14:15], v[14:15], v[110:111], v[110:111] op_sel_hi:[1,0,0]
    v_rcp_f32 v8, v8
    v_rcp_f32 v9, v9
    v_rcp_f32 v10, v10
    v_rcp_f32 v11, v11
    v_rcp_f32 v12, v12
    v_rcp_f32 v13, v13
    v_rcp_f32 v14, v14
    v_rcp_f32 v15, v15
    v_pk_mul_f32 v[8:9], v[8:9], v[212:213]
    v_pk_mul_f32 v[10:11], v[10:11], v[214:215]
    v_pk_mul_f32 v[12:13], v[12:13], v[236:237]
    v_pk_mul_f32 v[14:15], v[14:15], v[238:239]
    v_cvt_pk_bf16_f32 v24, v8, v9
    v_cvt_pk_bf16_f32 v26, v12, v13
    v_cvt_pk_bf16_f32 v25, v10, v11
    v_cvt_pk_bf16_f32 v27, v14, v15
    s_bitcmp1_b32 s11, 7
    v_permlane16_swap_b32 v24, v26
    v_permlane16_swap_b32 v25, v27
    s_cbranch_scc0 GS_18
    buffer_store_dwordx4 v[24:27], v1, s[48:51], s81 offen offset:2048 sc1
GS_18:
    s_waitcnt lgkmcnt(0)
    v_mfma_f32_16x16x32_bf16 v[120:123], v[64:67], v[40:43], v[120:123]
    ds_read_b64_tr_b16 v[72:73], v4 offset:6208
    ds_read_b64_tr_b16 v[74:75], v4 offset:6976
    v_mfma_f32_16x16x32_bf16 v[132:135], v[68:71], v[40:43], v[132:135]
    ds_read_b64_tr_b16 v[76:77], v4 offset:18496
    ds_read_b64_tr_b16 v[78:79], v4 offset:19264
    v_mfma_f32_16x16x32_bf16 v[144:147], v[64:67], v[44:47], v[144:147]
    ds_read_b128 v[8:11], v3 offset:0
    ds_read_b128 v[12:15], v3 offset:2048
    v_mfma_f32_16x16x32_bf16 v[156:159], v[68:71], v[44:47], v[156:159]
    ds_read_b128 v[16:19], v3 offset:4096
    ds_read_b128 v[20:23], v3 offset:6144
    v_mfma_f32_16x16x32_bf16 v[168:171], v[64:67], v[48:51], v[168:171]
    ds_read_b128 v[24:27], v3 offset:8192
    ds_read_b128 v[28:31], v3 offset:10240
    v_mfma_f32_16x16x32_bf16 v[180:183], v[68:71], v[48:51], v[180:183]
    ds_read_b128 v[80:83], v35 offset:128
    ds_read_b128 v[84:87], v35 offset:320
    v_mfma_f32_16x16x32_bf16 v[192:195], v[64:67], v[52:55], v[192:195]
    v_mfma_f32_16x16x32_bf16 v[204:207], v[68:71], v[52:55], v[204:207]
    v_mfma_f32_16x16x32_bf16 v[216:219], v[64:67], v[56:59], v[216:219]
    v_mfma_f32_16x16x32_bf16 v[228:231], v[68:71], v[56:59], v[228:231]
    v_mfma_f32_16x16x32_bf16 v[240:243], v[64:67], v[60:63], v[240:243]
    v_mfma_f32_16x16x32_bf16 v[252:255], v[68:71], v[60:63], v[252:255]
    s_waitcnt lgkmcnt(0)
    v_mfma_f32_16x16x32_bf16 v[120:123], v[72:75], v[8:11], v[120:123]
    ds_read_b64_tr_b16 v[64:65], v32 offset:64
    v_mfma_f32_16x16x32_bf16 v[132:135], v[76:79], v[8:11], v[132:135]
    ds_read_b64_tr_b16 v[66:67], v32 offset:832
    v_mfma_f32_16x16x32_bf16 v[144:147], v[72:75], v[12:15], v[144:147]
    ds_read_b64_tr_b16 v[68:69], v32 offset:12352
    v_mfma_f32_16x16x32_bf16 v[156:159], v[76:79], v[12:15], v[156:159]
    ds_read_b64_tr_b16 v[70:71], v32 offset:13120
    v_mfma_f32_16x16x32_bf16 v[168:171], v[72:75], v[16:19], v[168:171]
    ds_read_b128 v[40:43], v2 offset:49152
    v_mfma_f32_16x16x32_bf16 v[180:183], v[76:79], v[16:19], v[180:183]
    ds_read_b128 v[44:47], v2 offset:51200
    v_mfma_f32_16x16x32_bf16 v[192:195], v[72:75], v[20:23], v[192:195]
    ds_read_b128 v[48:51], v2 offset:53248
    v_mfma_f32_16x16x32_bf16 v[204:207], v[76:79], v[20:23], v[204:207]
    ds_read_b128 v[52:55], v2 offset:55296
    v_mfma_f32_16x16x32_bf16 v[216:219], v[72:75], v[24:27], v[216:219]
    ds_read_b128 v[56:59], v2 offset:57344
    v_mfma_f32_16x16x32_bf16 v[228:231], v[76:79], v[24:27], v[228:231]
    ds_read_b128 v[60:63], v2 offset:59392
    v_mfma_f32_16x16x32_bf16 v[240:243], v[72:75], v[28:31], v[240:243]
    v_mfma_f32_16x16x32_bf16 v[252:255], v[76:79], v[28:31], v[252:255]
    s_waitcnt lgkmcnt(0)
    v_mfma_f32_16x16x32_bf16 v[120:123], v[64:67], v[40:43], v[120:123]
    ds_read_b64_tr_b16 v[72:73], v32 offset:6208
    v_mfma_f32_16x16x32_bf16 v[132:135], v[68:71], v[40:43], v[132:135]
    ds_read_b64_tr_b16 v[74:75], v32 offset:6976
    v_mfma_f32_16x16x32_bf16 v[144:147], v[64:67], v[44:47], v[144:147]
    ds_read_b64_tr_b16 v[76:77], v32 offset:18496
    v_mfma_f32_16x16x32_bf16 v[156:159], v[68:71], v[44:47], v[156:159]
    ds_read_b64_tr_b16 v[78:79], v32 offset:19264
    v_mfma_f32_16x16x32_bf16 v[168:171], v[64:67], v[48:51], v[168:171]
    ds_read_b128 v[8:11], v3 offset:49152
    v_mfma_f32_16x16x32_bf16 v[180:183], v[68:71], v[48:51], v[180:183]
    ds_read_b128 v[12:15], v3 offset:51200
    v_mfma_f32_16x16x32_bf16 v[192:195], v[64:67], v[52:55], v[192:195]
    ds_read_b128 v[16:19], v3 offset:53248
    v_mfma_f32_16x16x32_bf16 v[204:207], v[68:71], v[52:55], v[204:207]
    ds_read_b128 v[20:23], v3 offset:55296
    v_mfma_f32_16x16x32_bf16 v[216:219], v[64:67], v[56:59], v[216:219]
    ds_read_b128 v[24:27], v3 offset:57344
    v_mfma_f32_16x16x32_bf16 v[228:231], v[68:71], v[56:59], v[228:231]
    ds_read_b128 v[28:31], v3 offset:59392
    v_mfma_f32_16x16x32_bf16 v[240:243], v[64:67], v[60:63], v[240:243]
    v_mfma_f32_16x16x32_bf16 v[252:255], v[68:71], v[60:63], v[252:255]
    s_waitcnt lgkmcnt(0)
    v_mfma_f32_16x16x32_bf16 v[120:123], v[72:75], v[8:11], v[120:123]
    v_mov_b32 v32, 152872
    v_mov_b32 v33, 1
    s_mov_b64 exec, 1
    ds_add_u32 v32, v33
    s_mov_b64 exec, -1
    v_mfma_f32_16x16x32_bf16 v[132:135], v[76:79], v[8:11], v[132:135]
    v_mfma_f32_16x16x32_bf16 v[144:147], v[72:75], v[12:15], v[144:147]
    v_mfma_f32_16x16x32_bf16 v[156:159], v[76:79], v[12:15], v[156:159]
    v_mfma_f32_16x16x32_bf16 v[168:171], v[72:75], v[16:19], v[168:171]
    v_mfma_f32_16x16x32_bf16 v[180:183], v[76:79], v[16:19], v[180:183]
    v_mfma_f32_16x16x32_bf16 v[192:195], v[72:75], v[20:23], v[192:195]
    v_mfma_f32_16x16x32_bf16 v[204:207], v[76:79], v[20:23], v[204:207]
    v_mfma_f32_16x16x32_bf16 v[216:219], v[72:75], v[24:27], v[216:219]
    v_mfma_f32_16x16x32_bf16 v[228:231], v[76:79], v[24:27], v[228:231]
    v_mfma_f32_16x16x32_bf16 v[240:243], v[72:75], v[28:31], v[240:243]
    v_mfma_f32_16x16x32_bf16 v[252:255], v[76:79], v[28:31], v[252:255]
    s_waitcnt vmcnt(0)
    s_add_u32 s86, s15, 1048576
    s_mov_b64 exec, 0xffff
    buffer_store_dwordx4 v[36:39], v6, s[44:47], s86 offen sc1
    s_mov_b64 exec, -1
    v_pk_fma_f32 v[120:121], v[80:81], v[88:89], v[120:121] op_sel_hi:[1,0,1]
    v_pk_fma_f32 v[122:123], v[82:83], v[88:89], v[122:123] op_sel_hi:[1,0,1]
    v_pk_fma_f32 v[144:145], v[80:81], v[92:93], v[144:145] op_sel_hi:[1,0,1]
    v_pk_fma_f32 v[146:147], v[82:83], v[92:93], v[146:147] op_sel_hi:[1,0,1]
    v_pk_mul_f32 v[8:9], v[120:121], v[120:121]
    v_pk_mul_f32 v[10:11], v[122:123], v[122:123]
    v_pk_mul_f32 v[12:13], v[144:145], v[144:145]
    v_pk_mul_f32 v[14:15], v[146:147], v[146:147]
    v_pk_fma_f32 v[8:9], v[8:9], v[88:89], v[90:91] op_sel:[0,1,1] op_sel_hi:[1,1,1]
    v_pk_fma_f32 v[10:11], v[10:11], v[88:89], v[90:91] op_sel:[0,1,1] op_sel_hi:[1,1,1]
    v_pk_fma_f32 v[12:13], v[12:13], v[92:93], v[94:95] op_sel:[0,1,1] op_sel_hi:[1,1,1]
    v_pk_fma_f32 v[14:15], v[14:15], v[92:93], v[94:95] op_sel:[0,1,1] op_sel_hi:[1,1,1]
    v_pk_mul_f32 v[8:9], v[8:9], v[120:121]
    v_pk_mul_f32 v[10:11], v[10:11], v[122:123]
    v_pk_mul_f32 v[12:13], v[12:13], v[144:145]
    v_pk_mul_f32 v[14:15], v[14:15], v[146:147]
    v_exp_f32 v8, v8
    v_pk_fma_f32 v[132:133], v[84:85], v[88:89], v[132:133] op_sel_hi:[1,0,1]
    v_exp_f32 v9, v9
    v_pk_fma_f32 v[134:135], v[86:87], v[88:89], v[134:135] op_sel_hi:[1,0,1]
    v_exp_f32 v10, v10
    v_pk_fma_f32 v[156:157], v[84:85], v[92:93], v[156:157] op_sel_hi:[1,0,1]
    v_exp_f32 v11, v11
    v_pk_fma_f32 v[158:159], v[86:87], v[92:93], v[158:159] op_sel_hi:[1,0,1]
    v_exp_f32 v12, v12
    v_pk_mul_f32 v[120:121], v[120:121], v[132:133]
    v_exp_f32 v13, v13
    v_pk_mul_f32 v[122:123], v[122:123], v[134:135]
    v_exp_f32 v14, v14
    v_pk_mul_f32 v[144:145], v[144:145], v[156:157]
    v_exp_f32 v15, v15
    v_pk_mul_f32 v[146:147], v[146:147], v[158:159]
    v_pk_fma_f32 v[8:9], v[8:9], v[90:91], v[90:91] op_sel_hi:[1,0,0]
    v_pk_fma_f32 v[10:11], v[10:11], v[90:91], v[90:91] op_sel_hi:[1,0,0]
    v_pk_fma_f32 v[12:13], v[12:13], v[94:95], v[94:95] op_sel_hi:[1,0,0]
    v_pk_fma_f32 v[14:15], v[14:15], v[94:95], v[94:95] op_sel_hi:[1,0,0]
    v_rcp_f32 v8, v8
    v_pk_fma_f32 v[168:169], v[80:81], v[96:97], v[168:169] op_sel_hi:[1,0,1]
    v_pk_fma_f32 v[170:171], v[82:83], v[96:97], v[170:171] op_sel_hi:[1,0,1]
    v_rcp_f32 v9, v9
    v_pk_fma_f32 v[192:193], v[80:81], v[100:101], v[192:193] op_sel_hi:[1,0,1]
    v_pk_fma_f32 v[194:195], v[82:83], v[100:101], v[194:195] op_sel_hi:[1,0,1]
    v_rcp_f32 v10, v10
    v_pk_mul_f32 v[16:17], v[168:169], v[168:169]
    v_pk_mul_f32 v[18:19], v[170:171], v[170:171]
    v_rcp_f32 v11, v11
    v_pk_mul_f32 v[20:21], v[192:193], v[192:193]
    v_pk_mul_f32 v[22:23], v[194:195], v[194:195]
    v_rcp_f32 v12, v12
    v_pk_fma_f32 v[16:17], v[16:17], v[96:97], v[98:99] op_sel:[0,1,1] op_sel_hi:[1,1,1]
    v_pk_fma_f32 v[18:19], v[18:19], v[96:97], v[98:99] op_sel:[0,1,1] op_sel_hi:[1,1,1]
    v_rcp_f32 v13, v13
    v_pk_fma_f32 v[20:21], v[20:21], v[100:101], v[102:103] op_sel:[0,1,1] op_sel_hi:[1,1,1]
    v_pk_fma_f32 v[22:23], v[22:23], v[100:101], v[102:103] op_sel:[0,1,1] op_sel_hi:[1,1,1]
    v_rcp_f32 v14, v14
    v_rcp_f32 v15, v15
    v_pk_mul_f32 v[8:9], v[8:9], v[120:121]
    v_pk_mul_f32 v[10:11], v[10:11], v[122:123]
    v_pk_mul_f32 v[12:13], v[12:13], v[144:145]
    v_pk_mul_f32 v[14:15], v[14:15], v[146:147]
    v_cvt_pk_bf16_f32 v24, v8, v9
    v_cvt_pk_bf16_f32 v26, v12, v13
    v_cvt_pk_bf16_f32 v25, v10, v11
    v_cvt_pk_bf16_f32 v27, v14, v15
    v_pk_mul_f32 v[16:17], v[16:17], v[168:169]
    v_pk_mul_f32 v[18:19], v[18:19], v[170:171]
    s_bitcmp1_b32 s11, 2
    v_permlane16_swap_b32 v24, v26
    v_permlane16_swap_b32 v25, v27
    s_cbranch_scc0 GS_19
    buffer_store_dwordx4 v[24:27], v1, s[48:51], s82 offen offset:0 sc1
GS_19:
    v_pk_mul_f32 v[20:21], v[20:21], v[192:193]
    v_pk_mul_f32 v[22:23], v[22:23], v[194:195]
    v_exp_f32 v16, v16
    v_pk_fma_f32 v[180:181], v[84:85], v[96:97], v[180:181] op_sel_hi:[1,0,1]
    v_exp_f32 v17, v17
    v_pk_fma_f32 v[182:183], v[86:87], v[96:97], v[182:183] op_sel_hi:[1,0,1]
    v_exp_f32 v18, v18
    v_pk_fma_f32 v[204:205], v[84:85], v[100:101], v[204:205] op_sel_hi:[1,0,1]
    v_exp_f32 v19, v19
    v_pk_fma_f32 v[206:207], v[86:87], v[100:101], v[206:207] op_sel_hi:[1,0,1]
    v_exp_f32 v20, v20
    v_pk_mul_f32 v[168:169], v[168:169], v[180:181]
    v_exp_f32 v21, v21
    v_pk_mul_f32 v[170:171], v[170:171], v[182:183]
    v_exp_f32 v22, v22
    v_pk_mul_f32 v[192:193], v[192:193], v[204:205]
    v_exp_f32 v23, v23
    v_pk_mul_f32 v[194:195], v[194:195], v[206:207]
    v_pk_fma_f32 v[16:17], v[16:17], v[98:99], v[98:99] op_sel_hi:[1,0,0]
    v_pk_fma_f32 v[18:19], v[18:19], v[98:99], v[98:99] op_sel_hi:[1,0,0]
    v_pk_fma_f32 v[20:21], v[20:21], v[102:103], v[102:103] op_sel_hi:[1,0,0]
    v_pk_fma_f32 v[22:23], v[22:23], v[102:103], v[102:103] op_sel_hi:[1,0,0]
    v_rcp_f32 v16, v16
    v_pk_fma_f32 v[216:217], v[80:81], v[104:105], v[216:217] op_sel_hi:[1,0,1]
    v_pk_fma_f32 v[218:219], v[82:83], v[104:105], v[218:219] op_sel_hi:[1,0,1]
    v_rcp_f32 v17, v17
    v_pk_fma_f32 v[240:241], v[80:81], v[108:109], v[240:241] op_sel_hi:[1,0,1]
    v_pk_fma_f32 v[242:243], v[82:83], v[108:109], v[242:243] op_sel_hi:[1,0,1]
    v_rcp_f32 v18, v18
    v_pk_mul_f32 v[8:9], v[216:217], v[216:217]
    v_pk_mul_f32 v[10:11], v[218:219], v[218:219]
    v_rcp_f32 v19, v19
    v_pk_mul_f32 v[12:13], v[240:241], v[240:241]
    v_pk_mul_f32 v[14:15], v[242:243], v[242:243]
    v_rcp_f32 v20, v20
    v_pk_fma_f32 v[8:9], v[8:9], v[104:105], v[106:107] op_sel:[0,1,1] op_sel_hi:[1,1,1]
    v_pk_fma_f32 v[10:11], v[10:11], v[104:105], v[106:107] op_sel:[0,1,1] op_sel_hi:[1,1,1]
    v_rcp_f32 v21, v21
    v_pk_fma_f32 v[12:13], v[12:13], v[108:109], v[110:111] op_sel:[0,1,1] op_sel_hi:[1,1,1]
    v_pk_fma_f32 v[14:15], v[14:15], v[108:109], v[110:111] op_sel:[0,1,1] op_sel_hi:[1,1,1]
    v_rcp_f32 v22, v22
    v_rcp_f32 v23, v23
    v_pk_mul_f32 v[16:17], v[16:17], v[168:169]
    v_pk_mul_f32 v[18:19], v[18:19], v[170:171]
    v_pk_mul_f32 v[20:21], v[20:21], v[192:193]
    v_pk_mul_f32 v[22:23], v[22:23], v[194:195]
    v_cvt_pk_bf16_f32 v28, v16, v17
    v_cvt_pk_bf16_f32 v30, v20, v21
    v_cvt_pk_bf16_f32 v29, v18, v19
    v_cvt_pk_bf16_f32 v31, v22, v23
    v_pk_mul_f32 v[8:9], v[8:9], v[216:217]
    v_pk_mul_f32 v[10:11], v[10:11], v[218:219]
    s_bitcmp1_b32 s11, 5
    v_permlane16_swap_b32 v28, v30
    v_permlane16_swap_b32 v29, v31
    s_cbranch_scc0 GS_20
    buffer_store_dwordx4 v[28:31], v1, s[48:51], s82 offen offset:1024 sc1
GS_20:
    v_pk_mul_f32 v[12:13], v[12:13], v[240:241]
    v_pk_mul_f32 v[14:15], v[14:15], v[242:243]
    v_exp_f32 v8, v8
    v_pk_fma_f32 v[228:229], v[84:85], v[104:105], v[228:229] op_sel_hi:[1,0,1]
    v_exp_f32 v9, v9
    v_pk_fma_f32 v[230:231], v[86:87], v[104:105], v[230:231] op_sel_hi:[1,0,1]
    v_exp_f32 v10, v10
    v_pk_fma_f32 v[252:253], v[84:85], v[108:109], v[252:253] op_sel_hi:[1,0,1]
    v_exp_f32 v11, v11
    v_pk_fma_f32 v[254:255], v[86:87], v[108:109], v[254:255] op_sel_hi:[1,0,1]
    v_exp_f32 v12, v12
    v_pk_mul_f32 v[216:217], v[216:217], v[228:229]
    v_exp_f32 v13, v13
    v_pk_mul_f32 v[218:219], v[218:219], v[230:231]
    v_exp_f32 v14, v14
    v_pk_mul_f32 v[240:241], v[240:241], v[252:253]
    v_exp_f32 v15, v15
    v_pk_mul_f32 v[242:243], v[242:243], v[254:255]
    v_pk_fma_f32 v[8:9], v[8:9], v[106:107], v[106:107] op_sel_hi:[1,0,0]
    v_pk_fma_f32 v[10:11], v[10:11], v[106:107], v[106:107] op_sel_hi:[1,0,0]
    v_pk_fma_f32 v[12:13], v[12:13], v[110:111], v[110:111] op_sel_hi:[1,0,0]
    v_pk_fma_f32 v[14:15], v[14:15], v[110:111], v[110:111] op_sel_hi:[1,0,0]
    v_rcp_f32 v8, v8
    v_rcp_f32 v9, v9
    v_rcp_f32 v10, v10
    v_rcp_f32 v11, v11
    v_rcp_f32 v12, v12
    v_rcp_f32 v13, v13
    v_rcp_f32 v14, v14
    v_rcp_f32 v15, v15
    v_pk_mul_f32 v[8:9], v[8:9], v[216:217]
    v_pk_mul_f32 v[10:11], v[10:11], v[218:219]
    v_pk_mul_f32 v[12:13], v[12:13], v[240:241]
    v_pk_mul_f32 v[14:15], v[14:15], v[242:243]
    v_cvt_pk_bf16_f32 v24, v8, v9
    v_cvt_pk_bf16_f32 v26, v12, v13
    v_cvt_pk_bf16_f32 v25, v10, v11
    v_cvt_pk_bf16_f32 v27, v14, v15
    s_bitcmp1_b32 s11, 8
    v_permlane16_swap_b32 v24, v26
    v_permlane16_swap_b32 v25, v27
    s_cbranch_scc0 GS_21
    buffer_store_dwordx4 v[24:27], v1, s[48:51], s82 offen offset:2048 sc1
GS_21:
L_PUB:
    v_mov_b32 v2, 152864
    v_mov_b32 v3, 1
    s_mov_b64 exec, 1
    ds_add_u32 v2, v3
    s_mov_b64 exec, -1
L_PUB2:
    s_waitcnt vmcnt(0)
    s_add_u32 s86, s15, 2097152
    s_mov_b64 exec, 0xffff
    buffer_store_dwordx4 v[36:39], v6, s[44:47], s86 offen sc1
    s_mov_b64 exec, -1
    s_branch L_SPART
L_DEAD:
    s_barrier
    s_add_u32 s83, s83, 1
    s_cmp_lt_u32 s83, 7
    s_cbranch_scc1 L_DEAD
    v_mov_b32 v32, 152872
    v_mov_b32 v33, 1
    s_mov_b64 exec, 1
    ds_add_u32 v32, v33
    s_mov_b64 exec, -1
    s_add_u32 s86, s15, 0
    s_mov_b64 exec, 0xffff
    buffer_store_dwordx4 v[36:39], v6, s[44:47], s86 offen sc1
    s_mov_b64 exec, -1
    s_add_u32 s86, s15, 1048576
    s_mov_b64 exec, 0xffff
    buffer_store_dwordx4 v[36:39], v6, s[44:47], s86 offen sc1
    s_mov_b64 exec, -1
    s_branch L_PUB
L_QKV:
    ds_read_b128 v[40:43], v2 offset:0
    ds_read_b64_tr_b16 v[64:65], v4 offset:0
    ds_read_b64_tr_b16 v[66:67], v4 offset:512
    ds_read_b128 v[44:47], v2 offset:2048
    ds_read_b64_tr_b16 v[68:69], v5 offset:0
    ds_read_b64_tr_b16 v[70:71], v5 offset:512
    ds_read_b128 v[48:51], v2 offset:4096
    ds_read_b64_tr_b16 v[72:73], v4 offset:1024
    ds_read_b64_tr_b16 v[74:75], v4 offset:1536
    ds_read_b128 v[52:55], v2 offset:6144
    ds_read_b64_tr_b16 v[76:77], v5 offset:1024
    ds_read_b64_tr_b16 v[78:79], v5 offset:1536
    s_waitcnt lgkmcnt(6)
    ds_read_b128 v[56:59], v2 offset:8192
    ds_read_b64_tr_b16 v[80:81], v4 offset:2048
    ds_read_b64_tr_b16 v[82:83], v4 offset:2560
    ds_read_b128 v[60:63], v2 offset:10240
    ds_read_b64_tr_b16 v[84:85], v5 offset:2048
    ds_read_b64_tr_b16 v[86:87], v5 offset:2560
L_MLQ:
    s_waitcnt lgkmcnt(0)
    v_mfma_f32_16x16x32_bf16 v[112:115], v[64:67], v[40:43], v[112:115]
    v_mfma_f32_16x16x32_bf16 v[116:119], v[68:71], v[40:43], v[116:119]
    ds_read_b128 v[8:11], v3 offset:0
    v_mfma_f32_16x16x32_bf16 v[120:123], v[40:43], v[72:75], v[120:123]
    ds_read_b64_tr_b16 v[88:89], v4 offset:6144
    v_mfma_f32_16x16x32_bf16 v[124:127], v[40:43], v[76:79], v[124:127]
    ds_read_b64_tr_b16 v[90:91], v4 offset:6656
    v_mfma_f32_16x16x32_bf16 v[128:131], v[40:43], v[80:83], v[128:131]
    ds_read_b128 v[12:15], v3 offset:2048
    v_mfma_f32_16x16x32_bf16 v[132:135], v[40:43], v[84:87], v[132:135]
    ds_read_b64_tr_b16 v[92:93], v5 offset:6144
    v_mfma_f32_16x16x32_bf16 v[136:139], v[64:67], v[44:47], v[136:139]
    v_mfma_f32_16x16x32_bf16 v[140:143], v[68:71], v[44:47], v[140:143]
    ds_read_b64_tr_b16 v[94:95], v5 offset:6656
    v_mfma_f32_16x16x32_bf16 v[144:147], v[44:47], v[72:75], v[144:147]
    ds_read_b128 v[16:19], v3 offset:4096
    v_mfma_f32_16x16x32_bf16 v[148:151], v[44:47], v[76:79], v[148:151]
    ds_read_b64_tr_b16 v[96:97], v4 offset:7168
    v_mfma_f32_16x16x32_bf16 v[152:155], v[44:47], v[80:83], v[152:155]
    ds_read_b64_tr_b16 v[98:99], v4 offset:7680
    v_mfma_f32_16x16x32_bf16 v[156:159], v[44:47], v[84:87], v[156:159]
    ds_read_b128 v[20:23], v3 offset:6144
    v_mfma_f32_16x16x32_bf16 v[160:163], v[64:67], v[48:51], v[160:163]
    v_mfma_f32_16x16x32_bf16 v[164:167], v[68:71], v[48:51], v[164:167]
    ds_read_b64_tr_b16 v[100:101], v5 offset:7168
    v_mfma_f32_16x16x32_bf16 v[168:171], v[48:51], v[72:75], v[168:171]
    ds_read_b64_tr_b16 v[102:103], v5 offset:7680
    v_mfma_f32_16x16x32_bf16 v[172:175], v[48:51], v[76:79], v[172:175]
    s_waitcnt lgkmcnt(6)
    ds_read_b128 v[24:27], v3 offset:8192
    v_mfma_f32_16x16x32_bf16 v[176:179], v[48:51], v[80:83], v[176:179]
    ds_read_b64_tr_b16 v[104:105], v4 offset:8192
    v_mfma_f32_16x16x32_bf16 v[180:183], v[48:51], v[84:87], v[180:183]
    ds_read_b64_tr_b16 v[106:107], v4 offset:8704
    v_mfma_f32_16x16x32_bf16 v[184:187], v[64:67], v[52:55], v[184:187]
    v_mfma_f32_16x16x32_bf16 v[188:191], v[68:71], v[52:55], v[188:191]
    ds_read_b128 v[28:31], v3 offset:10240
    v_mfma_f32_16x16x32_bf16 v[192:195], v[52:55], v[72:75], v[192:195]
    ds_read_b64_tr_b16 v[108:109], v5 offset:8192
    v_mfma_f32_16x16x32_bf16 v[196:199], v[52:55], v[76:79], v[196:199]
    ds_read_b64_tr_b16 v[110:111], v5 offset:8704
    v_mfma_f32_16x16x32_bf16 v[200:203], v[52:55], v[80:83], v[200:203]
    s_add_u32 s78, s78, 1
    v_mfma_f32_16x16x32_bf16 v[204:207], v[52:55], v[84:87], v[204:207]
    s_cmp_eq_u32 s78, 3
    v_mfma_f32_16x16x32_bf16 v[208:211], v[64:67], v[56:59], v[208:211]
    v_mfma_f32_16x16x32_bf16 v[212:215], v[68:71], v[56:59], v[212:215]
    s_cselect_b32 s86, 4294868992, s79
    v_mfma_f32_16x16x32_bf16 v[216:219], v[56:59], v[72:75], v[216:219]
    s_cselect_b32 s78, 0, s78
    v_mfma_f32_16x16x32_bf16 v[220:223], v[56:59], v[76:79], v[220:223]
    s_add_u32 s83, s83, 1
    v_mfma_f32_16x16x32_bf16 v[224:227], v[56:59], v[80:83], v[224:227]
    s_cmp_eq_u32 s83, 6
    v_mfma_f32_16x16x32_bf16 v[228:231], v[56:59], v[84:87], v[228:231]
    v_add_u32 v2, s86, v2
    v_mfma_f32_16x16x32_bf16 v[232:235], v[64:67], v[60:63], v[232:235]
    v_mfma_f32_16x16x32_bf16 v[236:239], v[68:71], v[60:63], v[236:239]
    v_add_u32 v4, s86, v4
    v_mfma_f32_16x16x32_bf16 v[240:243], v[60:63], v[72:75], v[240:243]
    v_add_u32 v5, s86, v5
    v_mfma_f32_16x16x32_bf16 v[244:247], v[60:63], v[76:79], v[244:247]
    v_add_u32 v3, s86, v3
    v_mfma_f32_16x16x32_bf16 v[248:251], v[60:63], v[80:83], v[248:251]
    v_mfma_f32_16x16x32_bf16 v[252:255], v[60:63], v[84:87], v[252:255]
    s_waitcnt lgkmcnt(0)
    s_barrier
    s_cbranch_scc1 L_MXQ
    v_mfma_f32_16x16x32_bf16 v[112:115], v[88:91], v[8:11], v[112:115]
    v_mfma_f32_16x16x32_bf16 v[116:119], v[92:95], v[8:11], v[116:119]
    ds_read_b128 v[40:43], v2 offset:0
    v_mfma_f32_16x16x32_bf16 v[120:123], v[8:11], v[96:99], v[120:123]
    ds_read_b64_tr_b16 v[64:65], v4 offset:0
    v_mfma_f32_16x16x32_bf16 v[124:127], v[8:11], v[100:103], v[124:127]
    ds_read_b64_tr_b16 v[66:67], v4 offset:512
    v_mfma_f32_16x16x32_bf16 v[128:131], v[8:11], v[104:107], v[128:131]
    v_mfma_f32_16x16x32_bf16 v[132:135], v[8:11], v[108:111], v[132:135]
    ds_read_b128 v[44:47], v2 offset:2048
    v_mfma_f32_16x16x32_bf16 v[136:139], v[88:91], v[12:15], v[136:139]
    ds_read_b64_tr_b16 v[68:69], v5 offset:0
    v_mfma_f32_16x16x32_bf16 v[140:143], v[92:95], v[12:15], v[140:143]
    ds_read_b64_tr_b16 v[70:71], v5 offset:512
    v_mfma_f32_16x16x32_bf16 v[144:147], v[12:15], v[96:99], v[144:147]
    v_mfma_f32_16x16x32_bf16 v[148:151], v[12:15], v[100:103], v[148:151]
    ds_read_b128 v[48:51], v2 offset:4096
    v_mfma_f32_16x16x32_bf16 v[152:155], v[12:15], v[104:107], v[152:155]
    ds_read_b64_tr_b16 v[72:73], v4 offset:1024
    v_mfma_f32_16x16x32_bf16 v[156:159], v[12:15], v[108:111], v[156:159]
    ds_read_b64_tr_b16 v[74:75], v4 offset:1536
    v_mfma_f32_16x16x32_bf16 v[160:163], v[88:91], v[16:19], v[160:163]
    v_mfma_f32_16x16x32_bf16 v[164:167], v[92:95], v[16:19], v[164:167]
    ds_read_b128 v[52:55], v2 offset:6144
    v_mfma_f32_16x16x32_bf16 v[168:171], v[16:19], v[96:99], v[168:171]
    ds_read_b64_tr_b16 v[76:77], v5 offset:1024
    v_mfma_f32_16x16x32_bf16 v[172:175], v[16:19], v[100:103], v[172:175]
    ds_read_b64_tr_b16 v[78:79], v5 offset:1536
    v_mfma_f32_16x16x32_bf16 v[176:179], v[16:19], v[104:107], v[176:179]
    v_mfma_f32_16x16x32_bf16 v[180:183], v[16:19], v[108:111], v[180:183]
    s_waitcnt lgkmcnt(6)
    ds_read_b128 v[56:59], v2 offset:8192
    v_mfma_f32_16x16x32_bf16 v[184:187], v[88:91], v[20:23], v[184:187]
    ds_read_b64_tr_b16 v[80:81], v4 offset:2048
    v_mfma_f32_16x16x32_bf16 v[188:191], v[92:95], v[20:23], v[188:191]
    ds_read_b64_tr_b16 v[82:83], v4 offset:2560
    v_mfma_f32_16x16x32_bf16 v[192:195], v[20:23], v[96:99], v[192:195]
    v_mfma_f32_16x16x32_bf16 v[196:199], v[20:23], v[100:103], v[196:199]
    ds_read_b128 v[60:63], v2 offset:10240
    v_mfma_f32_16x16x32_bf16 v[200:203], v[20:23], v[104:107], v[200:203]
    ds_read_b64_tr_b16 v[84:85], v5 offset:2048
    v_mfma_f32_16x16x32_bf16 v[204:207], v[20:23], v[108:111], v[204:207]
    ds_read_b64_tr_b16 v[86:87], v5 offset:2560
    v_mfma_f32_16x16x32_bf16 v[208:211], v[88:91], v[24:27], v[208:211]
    v_mfma_f32_16x16x32_bf16 v[212:215], v[92:95], v[24:27], v[212:215]
    v_mfma_f32_16x16x32_bf16 v[216:219], v[24:27], v[96:99], v[216:219]
    v_mfma_f32_16x16x32_bf16 v[220:223], v[24:27], v[100:103], v[220:223]
    v_mfma_f32_16x16x32_bf16 v[224:227], v[24:27], v[104:107], v[224:227]
    v_mfma_f32_16x16x32_bf16 v[228:231], v[24:27], v[108:111], v[228:231]
    v_mfma_f32_16x16x32_bf16 v[232:235], v[88:91], v[28:31], v[232:235]
    v_mfma_f32_16x16x32_bf16 v[236:239], v[92:95], v[28:31], v[236:239]
    v_mfma_f32_16x16x32_bf16 v[240:243], v[28:31], v[96:99], v[240:243]
    v_mfma_f32_16x16x32_bf16 v[244:247], v[28:31], v[100:103], v[244:247]
    v_mfma_f32_16x16x32_bf16 v[248:251], v[28:31], v[104:107], v[248:251]
    v_mfma_f32_16x16x32_bf16 v[252:255], v[28:31], v[108:111], v[252:255]
    s_branch L_MLQ
L_MXQ:
    v_mfma_f32_16x16x32_bf16 v[112:115], v[88:91], v[8:11], v[112:115]
    ds_read_b64_tr_b16 v[64:65], v4 offset:1024
    ds_read_b64_tr_b16 v[66:67], v4 offset:1536
    v_mfma_f32_16x16x32_bf16 v[116:119], v[92:95], v[8:11], v[116:119]
    ds_read_b64_tr_b16 v[68:69], v5 offset:1024
    ds_read_b64_tr_b16 v[70:71], v5 offset:1536
    v_mfma_f32_16x16x32_bf16 v[120:123], v[8:11], v[96:99], v[120:123]
    ds_read_b128 v[40:43], v2 offset:0
    ds_read_b128 v[44:47], v2 offset:2048
    v_mfma_f32_16x16x32_bf16 v[124:127], v[8:11], v[100:103], v[124:127]
    ds_read_b128 v[48:51], v2 offset:4096
    ds_read_b128 v[52:55], v2 offset:6144
    v_mfma_f32_16x16x32_bf16 v[128:131], v[8:11], v[104:107], v[128:131]
    ds_read_b128 v[56:59], v2 offset:8192
    ds_read_b128 v[60:63], v2 offset:10240
    v_mfma_f32_16x16x32_bf16 v[132:135], v[8:11], v[108:111], v[132:135]
    ds_read_b64_tr_b16 v[72:73], v4 offset:2048
    ds_read_b64_tr_b16 v[74:75], v4 offset:2560
    v_mfma_f32_16x16x32_bf16 v[136:139], v[88:91], v[12:15], v[136:139]
    ds_read_b64_tr_b16 v[76:77], v5 offset:2048
    ds_read_b64_tr_b16 v[78:79], v5 offset:2560
    v_mfma_f32_16x16x32_bf16 v[140:143], v[92:95], v[12:15], v[140:143]
    s_mov_b32 s70, 0x3fb8aa3b
    s_mov_b32 s71, 0x3fb8aa3b
    v_mfma_f32_16x16x32_bf16 v[144:147], v[12:15], v[96:99], v[144:147]
    s_mov_b32 s72, 0x358637bd
    s_mov_b32 s73, 0x358637bd
    v_mfma_f32_16x16x32_bf16 v[148:151], v[12:15], v[100:103], v[148:151]
    s_mov_b32 s74, 0xffff0000
    s_mov_b32 s75, 0xffff0000
    v_mfma_f32_16x16x32_bf16 v[152:155], v[12:15], v[104:107], v[152:155]
    s_sub_u32 s87, s7, 15
    s_lshl_b32 s87, s87, 1
    v_mfma_f32_16x16x32_bf16 v[156:159], v[12:15], v[108:111], v[156:159]
    s_add_u32 s87, s87, s14
    s_mul_i32 s77, s87, 73728
    v_mfma_f32_16x16x32_bf16 v[160:163], v[88:91], v[16:19], v[160:163]
    s_add_u32 s77, s77, 1048576
    s_lshl_b32 s78, s6, 1
    v_mfma_f32_16x16x32_bf16 v[164:167], v[92:95], v[16:19], v[164:167]
    s_add_u32 s78, s78, s13
    s_mul_i32 s78, s78, 3072
    v_mfma_f32_16x16x32_bf16 v[168:171], v[16:19], v[96:99], v[168:171]
    s_add_u32 s78, s78, s77
    s_waitcnt vmcnt(0)
    v_mfma_f32_16x16x32_bf16 v[172:175], v[16:19], v[100:103], v[172:175]
    v_add_u32 v32, 49152, v4
    v_add_u32 v33, 49152, v5
    v_mfma_f32_16x16x32_bf16 v[176:179], v[16:19], v[104:107], v[176:179]
    v_and_b32 v34, 15, v0
    s_mul_i32 s86, s13, 1536
    v_mfma_f32_16x16x32_bf16 v[180:183], v[16:19], v[108:111], v[180:183]
    s_add_u32 s86, s86, 147456
    v_lshl_add_u32 v34, v34, 4, s86
    v_mfma_f32_16x16x32_bf16 v[184:187], v[88:91], v[20:23], v[184:187]
    v_lshrrev_b32 v7, 4, v0
    s_mul_i32 s79, s14, 384
    v_mfma_f32_16x16x32_bf16 v[188:191], v[92:95], v[20:23], v[188:191]
    s_add_u32 s79, s79, 151296
    v_lshl_add_u32 v35, v7, 4, s79
    v_mfma_f32_16x16x32_bf16 v[192:195], v[20:23], v[96:99], v[192:195]
    s_mul_i32 s86, s13, 384
    s_add_u32 s86, s86, 150528
    v_mfma_f32_16x16x32_bf16 v[196:199], v[20:23], v[100:103], v[196:199]
    v_lshl_add_u32 v7, v7, 4, s86
    v_mfma_f32_16x16x32_bf16 v[200:203], v[20:23], v[104:107], v[200:203]
    v_mfma_f32_16x16x32_bf16 v[204:207], v[20:23], v[108:111], v[204:207]
    v_mfma_f32_16x16x32_bf16 v[208:211], v[88:91], v[24:27], v[208:211]
    v_mfma_f32_16x16x32_bf16 v[212:215], v[92:95], v[24:27], v[212:215]
    v_mfma_f32_16x16x32_bf16 v[216:219], v[24:27], v[96:99], v[216:219]
    v_mfma_f32_16x16x32_bf16 v[220:223], v[24:27], v[100:103], v[220:223]
    v_mfma_f32_16x16x32_bf16 v[224:227], v[24:27], v[104:107], v[224:227]
    v_mfma_f32_16x16x32_bf16 v[228:231], v[24:27], v[108:111], v[228:231]
    v_mfma_f32_16x16x32_bf16 v[232:235], v[88:91], v[28:31], v[232:235]
    v_mfma_f32_16x16x32_bf16 v[236:239], v[92:95], v[28:31], v[236:239]
    v_mfma_f32_16x16x32_bf16 v[240:243], v[28:31], v[96:99], v[240:243]
    v_mfma_f32_16x16x32_bf16 v[244:247], v[28:31], v[100:103], v[244:247]
    v_mfma_f32_16x16x32_bf16 v[248:251], v[28:31], v[104:107], v[248:251]
    v_mfma_f32_16x16x32_bf16 v[252:255], v[28:31], v[108:111], v[252:255]
    s_waitcnt lgkmcnt(0)
    v_mfma_f32_16x16x32_bf16 v[120:123], v[40:43], v[64:67], v[120:123]
    ds_read_b64_tr_b16 v[80:81], v4 offset:7168
    v_mfma_f32_16x16x32_bf16 v[124:127], v[40:43], v[68:71], v[124:127]
    ds_read_b64_tr_b16 v[82:83], v4 offset:7680
    v_mfma_f32_16x16x32_bf16 v[128:131], v[40:43], v[72:75], v[128:131]
    ds_read_b64_tr_b16 v[84:85], v5 offset:7168
    v_mfma_f32_16x16x32_bf16 v[132:135], v[40:43], v[76:79], v[132:135]
    ds_read_b64_tr_b16 v[86:87], v5 offset:7680
    v_mfma_f32_16x16x32_bf16 v[144:147], v[44:47], v[64:67], v[144:147]
    ds_read_b128 v[8:11], v3 offset:0
    v_mfma_f32_16x16x32_bf16 v[148:151], v[44:47], v[68:71], v[148:151]
    ds_read_b128 v[12:15], v3 offset:2048
    v_mfma_f32_16x16x32_bf16 v[152:155], v[44:47], v[72:75], v[152:155]
    ds_read_b128 v[16:19], v3 offset:4096
    v_mfma_f32_16x16x32_bf16 v[156:159], v[44:47], v[76:79], v[156:159]
    ds_read_b128 v[20:23], v3 offset:6144
    v_mfma_f32_16x16x32_bf16 v[168:171], v[48:51], v[64:67], v[168:171]
    ds_read_b128 v[24:27], v3 offset:8192
    v_mfma_f32_16x16x32_bf16 v[172:175], v[48:51], v[68:71], v[172:175]
    ds_read_b128 v[28:31], v3 offset:10240
    v_mfma_f32_16x16x32_bf16 v[176:179], v[48:51], v[72:75], v[176:179]
    ds_read_b64_tr_b16 v[88:89], v4 offset:8192
    v_mfma_f32_16x16x32_bf16 v[180:183], v[48:51], v[76:79], v[180:183]
    ds_read_b64_tr_b16 v[90:91], v4 offset:8704
    v_mfma_f32_16x16x32_bf16 v[192:195], v[52:55], v[64:67], v[192:195]
    ds_read_b64_tr_b16 v[92:93], v5 offset:8192
    v_mfma_f32_16x16x32_bf16 v[196:199], v[52:55], v[68:71], v[196:199]
    ds_read_b64_tr_b16 v[94:95], v5 offset:8704
    v_mfma_f32_16x16x32_bf16 v[200:203], v[52:55], v[72:75], v[200:203]
    v_mfma_f32_16x16x32_bf16 v[204:207], v[52:55], v[76:79], v[204:207]
    v_mfma_f32_16x16x32_bf16 v[216:219], v[56:59], v[64:67], v[216:219]
    v_mfma_f32_16x16x32_bf16 v[220:223], v[56:59], v[68:71], v[220:223]
    v_mfma_f32_16x16x32_bf16 v[224:227], v[56:59], v[72:75], v[224:227]
    v_mfma_f32_16x16x32_bf16 v[228:231], v[56:59], v[76:79], v[228:231]
    v_mfma_f32_16x16x32_bf16 v[240:243], v[60:63], v[64:67], v[240:243]
    v_mfma_f32_16x16x32_bf16 v[244:247], v[60:63], v[68:71], v[244:247]
    v_mfma_f32_16x16x32_bf16 v[248:251], v[60:63], v[72:75], v[248:251]
    v_mfma_f32_16x16x32_bf16 v[252:255], v[60:63], v[76:79], v[252:255]
    s_waitcnt lgkmcnt(0)
    s_barrier
    v_mfma_f32_16x16x32_bf16 v[120:123], v[8:11], v[80:83], v[120:123]
    ds_read_b64_tr_b16 v[64:65], v32 offset:1024
    v_mfma_f32_16x16x32_bf16 v[124:127], v[8:11], v[84:87], v[124:127]
    ds_read_b64_tr_b16 v[66:67], v32 offset:1536
    v_mfma_f32_16x16x32_bf16 v[128:131], v[8:11], v[88:91], v[128:131]
    ds_read_b64_tr_b16 v[68:69], v33 offset:1024
    v_mfma_f32_16x16x32_bf16 v[132:135], v[8:11], v[92:95], v[132:135]
    ds_read_b64_tr_b16 v[70:71], v33 offset:1536
    v_mfma_f32_16x16x32_bf16 v[144:147], v[12:15], v[80:83], v[144:147]
    ds_read_b128 v[40:43], v2 offset:49152
    v_mfma_f32_16x16x32_bf16 v[148:151], v[12:15], v[84:87], v[148:151]
    ds_read_b128 v[44:47], v2 offset:51200
    v_mfma_f32_16x16x32_bf16 v[152:155], v[12:15], v[88:91], v[152:155]
    ds_read_b128 v[48:51], v2 offset:53248
    v_mfma_f32_16x16x32_bf16 v[156:159], v[12:15], v[92:95], v[156:159]
    ds_read_b128 v[52:55], v2 offset:55296
    v_mfma_f32_16x16x32_bf16 v[168:171], v[16:19], v[80:83], v[168:171]
    ds_read_b128 v[56:59], v2 offset:57344
    v_mfma_f32_16x16x32_bf16 v[172:175], v[16:19], v[84:87], v[172:175]
    ds_read_b128 v[60:63], v2 offset:59392
    v_mfma_f32_16x16x32_bf16 v[176:179], v[16:19], v[88:91], v[176:179]
    ds_read_b64_tr_b16 v[72:73], v32 offset:2048
    v_mfma_f32_16x16x32_bf16 v[180:183], v[16:19], v[92:95], v[180:183]
    ds_read_b64_tr_b16 v[74:75], v32 offset:2560
    v_mfma_f32_16x16x32_bf16 v[192:195], v[20:23], v[80:83], v[192:195]
    ds_read_b64_tr_b16 v[76:77], v33 offset:2048
    v_mfma_f32_16x16x32_bf16 v[196:199], v[20:23], v[84:87], v[196:199]
    ds_read_b64_tr_b16 v[78:79], v33 offset:2560
    v_mfma_f32_16x16x32_bf16 v[200:203], v[20:23], v[88:91], v[200:203]
    v_mfma_f32_16x16x32_bf16 v[204:207], v[20:23], v[92:95], v[204:207]
    v_mfma_f32_16x16x32_bf16 v[216:219], v[24:27], v[80:83], v[216:219]
    v_mfma_f32_16x16x32_bf16 v[220:223], v[24:27], v[84:87], v[220:223]
    v_mfma_f32_16x16x32_bf16 v[224:227], v[24:27], v[88:91], v[224:227]
    v_mfma_f32_16x16x32_bf16 v[228:231], v[24:27], v[92:95], v[228:231]
    v_mfma_f32_16x16x32_bf16 v[240:243], v[28:31], v[80:83], v[240:243]
    v_mfma_f32_16x16x32_bf16 v[244:247], v[28:31], v[84:87], v[244:247]
    v_mfma_f32_16x16x32_bf16 v[248:251], v[28:31], v[88:91], v[248:251]
    v_mfma_f32_16x16x32_bf16 v[252:255], v[28:31], v[92:95], v[252:255]
    s_waitcnt lgkmcnt(0)
    v_mfma_f32_16x16x32_bf16 v[120:123], v[40:43], v[64:67], v[120:123]
    ds_read_b64_tr_b16 v[80:81], v32 offset:7168
    v_mfma_f32_16x16x32_bf16 v[124:127], v[40:43], v[68:71], v[124:127]
    ds_read_b64_tr_b16 v[82:83], v32 offset:7680
    v_mfma_f32_16x16x32_bf16 v[128:131], v[40:43], v[72:75], v[128:131]
    ds_read_b64_tr_b16 v[84:85], v33 offset:7168
    v_mfma_f32_16x16x32_bf16 v[132:135], v[40:43], v[76:79], v[132:135]
    ds_read_b64_tr_b16 v[86:87], v33 offset:7680
    v_mfma_f32_16x16x32_bf16 v[144:147], v[44:47], v[64:67], v[144:147]
    ds_read_b128 v[8:11], v3 offset:49152
    v_mfma_f32_16x16x32_bf16 v[148:151], v[44:47], v[68:71], v[148:151]
    ds_read_b128 v[12:15], v3 offset:51200
    v_mfma_f32_16x16x32_bf16 v[152:155], v[44:47], v[72:75], v[152:155]
    ds_read_b128 v[16:19], v3 offset:53248
    v_mfma_f32_16x16x32_bf16 v[156:159], v[44:47], v[76:79], v[156:159]
    ds_read_b128 v[20:23], v3 offset:55296
    v_mfma_f32_16x16x32_bf16 v[168:171], v[48:51], v[64:67], v[168:171]
    ds_read_b128 v[24:27], v3 offset:57344
    v_mfma_f32_16x16x32_bf16 v[172:175], v[48:51], v[68:71], v[172:175]
    ds_read_b128 v[28:31], v3 offset:59392
    v_mfma_f32_16x16x32_bf16 v[176:179], v[48:51], v[72:75], v[176:179]
    ds_read_b64_tr_b16 v[88:89], v32 offset:8192
    v_mfma_f32_16x16x32_bf16 v[180:183], v[48:51], v[76:79], v[180:183]
    ds_read_b64_tr_b16 v[90:91], v32 offset:8704
    v_mfma_f32_16x16x32_bf16 v[192:195], v[52:55], v[64:67], v[192:195]
    ds_read_b64_tr_b16 v[92:93], v33 offset:8192
    v_mfma_f32_16x16x32_bf16 v[196:199], v[52:55], v[68:71], v[196:199]
    ds_read_b64_tr_b16 v[94:95], v33 offset:8704
    v_mfma_f32_16x16x32_bf16 v[200:203], v[52:55], v[72:75], v[200:203]
    v_mfma_f32_16x16x32_bf16 v[204:207], v[52:55], v[76:79], v[204:207]
    v_mfma_f32_16x16x32_bf16 v[216:219], v[56:59], v[64:67], v[216:219]
    v_mfma_f32_16x16x32_bf16 v[220:223], v[56:59], v[68:71], v[220:223]
    v_mfma_f32_16x16x32_bf16 v[224:227], v[56:59], v[72:75], v[224:227]
    v_mfma_f32_16x16x32_bf16 v[228:231], v[56:59], v[76:79], v[228:231]
    v_mfma_f32_16x16x32_bf16 v[240:243], v[60:63], v[64:67], v[240:243]
    v_mfma_f32_16x16x32_bf16 v[244:247], v[60:63], v[68:71], v[244:247]
    v_mfma_f32_16x16x32_bf16 v[248:251], v[60:63], v[72:75], v[248:251]
    v_mfma_f32_16x16x32_bf16 v[252:255], v[60:63], v[76:79], v[252:255]
    s_waitcnt lgkmcnt(0)
    v_mfma_f32_16x16x32_bf16 v[240:243], v[28:31], v[80:83], v[240:243]
    v_and_b32 v75, 15, v0
    v_lshl_add_u32 v75, v75, 2, s79
    v_mfma_f32_16x16x32_bf16 v[244:247], v[28:31], v[84:87], v[244:247]
    ds_read_b32 v72, v75 offset:128
    ds_read_b32 v73, v75 offset:192
    v_mfma_f32_16x16x32_bf16 v[248:251], v[28:31], v[88:91], v[248:251]
    ds_read_b32 v74, v75 offset:256
    ds_read_b32 v75, v75 offset:320
    v_mfma_f32_16x16x32_bf16 v[252:255], v[28:31], v[92:95], v[252:255]
    v_mov_b32 v76, 0x3f803f80
    v_mov_b32 v77, 0x3f803f80
    v_mfma_f32_16x16x32_bf16 v[216:219], v[24:27], v[80:83], v[216:219]
    v_mov_b32 v78, 0x3f803f80
    v_mov_b32 v79, 0x3f803f80
    v_mfma_f32_16x16x32_bf16 v[220:223], v[24:27], v[84:87], v[220:223]
    ds_read_b128 v[108:111], v7 offset:320
    ds_read_b128 v[104:107], v7 offset:256
    v_mfma_f32_16x16x32_bf16 v[224:227], v[24:27], v[88:91], v[224:227]
    ds_read_b64_tr_b16 v[64:65], v4 offset:0
    ds_read_b64_tr_b16 v[66:67], v4 offset:512
    v_mfma_f32_16x16x32_bf16 v[228:231], v[24:27], v[92:95], v[228:231]
    ds_read_b64_tr_b16 v[68:69], v5 offset:0
    ds_read_b64_tr_b16 v[70:71], v5 offset:512
    v_mfma_f32_16x16x32_bf16 v[192:195], v[20:23], v[80:83], v[192:195]
    ds_read_b128 v[28:31], v7 offset:1856
    ds_read_b128 v[24:27], v7 offset:1792
    v_mfma_f32_16x16x32_bf16 v[196:199], v[20:23], v[84:87], v[196:199]
    s_waitcnt lgkmcnt(4)
    ds_read_b128 v[40:43], v2 offset:0
    v_mfma_f32_16x16x32_bf16 v[200:203], v[20:23], v[88:91], v[200:203]
    ds_read_b128 v[44:47], v2 offset:2048
    ds_read_b128 v[48:51], v2 offset:4096
    v_mfma_f32_16x16x32_bf16 v[204:207], v[20:23], v[92:95], v[204:207]
    ds_read_b128 v[52:55], v2 offset:6144
    ds_read_b128 v[56:59], v2 offset:8192
    v_mfma_f32_16x16x32_bf16 v[168:171], v[16:19], v[80:83], v[168:171]
    ds_read_b128 v[60:63], v2 offset:10240
    v_mfma_f32_16x16x32_bf16 v[172:175], v[16:19], v[84:87], v[172:175]
    v_mfma_f32_16x16x32_bf16 v[176:179], v[16:19], v[88:91], v[176:179]
    v_mfma_f32_16x16x32_bf16 v[180:183], v[16:19], v[92:95], v[180:183]
    v_mfma_f32_16x16x32_bf16 v[144:147], v[12:15], v[80:83], v[144:147]
    v_mfma_f32_16x16x32_bf16 v[148:151], v[12:15], v[84:87], v[148:151]
    v_mfma_f32_16x16x32_bf16 v[152:155], v[12:15], v[88:91], v[152:155]
    v_mfma_f32_16x16x32_bf16 v[156:159], v[12:15], v[92:95], v[156:159]
    v_mfma_f32_16x16x32_bf16 v[120:123], v[8:11], v[80:83], v[120:123]
    v_mfma_f32_16x16x32_bf16 v[124:127], v[8:11], v[84:87], v[124:127]
    v_mfma_f32_16x16x32_bf16 v[128:131], v[8:11], v[88:91], v[128:131]
    v_mfma_f32_16x16x32_bf16 v[132:135], v[8:11], v[92:95], v[132:135]
    s_waitcnt lgkmcnt(6)
    ds_read_b128 v[100:103], v7 offset:192
    ds_read_b128 v[20:23], v7 offset:1728
    ds_read_b128 v[96:99], v7 offset:128
    ds_read_b128 v[16:19], v7 offset:1664
    ds_read_b128 v[92:95], v7 offset:64
    ds_read_b128 v[12:15], v7 offset:1600
    ds_read_b128 v[88:91], v7 offset:0
    ds_read_b128 v[8:11], v7 offset:1536
    v_pk_mul_f32 v[224:225], v[224:225], v[104:105]
    v_pk_mul_f32 v[226:227], v[226:227], v[106:107]
    v_pk_mul_f32 v[248:249], v[248:249], v[108:109]
    v_pk_mul_f32 v[250:251], v[250:251], v[110:111]
    v_pk_mul_f32 v[228:229], v[228:229], v[104:105]
    v_pk_mul_f32 v[230:231], v[230:231], v[106:107]
    v_pk_mul_f32 v[252:253], v[252:253], v[108:109]
    v_pk_mul_f32 v[254:255], v[254:255], v[110:111]
    v_pk_fma_f32 v[216:217], v[216:217], v[104:105], s[72:73]
    v_pk_fma_f32 v[218:219], v[218:219], v[106:107], s[72:73]
    v_pk_fma_f32 v[240:241], v[240:241], v[108:109], s[72:73]
    v_pk_fma_f32 v[242:243], v[242:243], v[110:111], s[72:73]
    v_pk_fma_f32 v[220:221], v[220:221], v[104:105], s[72:73]
    v_pk_fma_f32 v[222:223], v[222:223], v[106:107], s[72:73]
    v_pk_fma_f32 v[244:245], v[244:245], v[108:109], s[72:73]
    v_pk_fma_f32 v[246:247], v[246:247], v[110:111], s[72:73]
    v_pk_fma_f32 v[224:225], v[24:25], v[74:75], v[224:225] op_sel:[0,0,0] op_sel_hi:[1,0,1]
    v_pk_fma_f32 v[226:227], v[26:27], v[74:75], v[226:227] op_sel:[0,0,0] op_sel_hi:[1,0,1]
    v_pk_fma_f32 v[248:249], v[28:29], v[74:75], v[248:249] op_sel:[0,0,0] op_sel_hi:[1,0,1]
    v_pk_fma_f32 v[250:251], v[30:31], v[74:75], v[250:251] op_sel:[0,0,0] op_sel_hi:[1,0,1]
    v_pk_fma_f32 v[228:229], v[24:25], v[74:75], v[228:229] op_sel:[0,1,0] op_sel_hi:[1,1,1]
    v_pk_fma_f32 v[230:231], v[26:27], v[74:75], v[230:231] op_sel:[0,1,0] op_sel_hi:[1,1,1]
    v_pk_fma_f32 v[252:253], v[28:29], v[74:75], v[252:253] op_sel:[0,1,0] op_sel_hi:[1,1,1]
    v_pk_fma_f32 v[254:255], v[30:31], v[74:75], v[254:255] op_sel:[0,1,0] op_sel_hi:[1,1,1]
    v_pk_fma_f32 v[216:217], v[24:25], v[72:73], v[216:217] op_sel:[0,0,0] op_sel_hi:[1,0,1]
    v_pk_fma_f32 v[218:219], v[26:27], v[72:73], v[218:219] op_sel:[0,0,0] op_sel_hi:[1,0,1]
    v_pk_fma_f32 v[240:241], v[28:29], v[72:73], v[240:241] op_sel:[0,0,0] op_sel_hi:[1,0,1]
    v_pk_fma_f32 v[242:243], v[30:31], v[72:73], v[242:243] op_sel:[0,0,0] op_sel_hi:[1,0,1]
    v_pk_fma_f32 v[220:221], v[24:25], v[72:73], v[220:221] op_sel:[0,1,0] op_sel_hi:[1,1,1]
    v_pk_fma_f32 v[222:223], v[26:27], v[72:73], v[222:223] op_sel:[0,1,0] op_sel_hi:[1,1,1]
    v_pk_fma_f32 v[244:245], v[28:29], v[72:73], v[244:245] op_sel:[0,1,0] op_sel_hi:[1,1,1]
    v_pk_fma_f32 v[246:247], v[30:31], v[72:73], v[246:247] op_sel:[0,1,0] op_sel_hi:[1,1,1]
    v_cvt_pk_bf16_f32 v224, v224, v225
    v_cvt_pk_bf16_f32 v225, v226, v227
    v_cvt_pk_bf16_f32 v226, v248, v249
    v_cvt_pk_bf16_f32 v227, v250, v251
    v_cvt_pk_bf16_f32 v228, v228, v229
    v_cvt_pk_bf16_f32 v229, v230, v231
    v_cvt_pk_bf16_f32 v230, v252, v253
    v_cvt_pk_bf16_f32 v231, v254, v255
    v_pk_mul_f32 v[248:249], v[216:217], s[70:71]
    v_pk_mul_f32 v[250:251], v[218:219], s[70:71]
    v_pk_mul_f32 v[252:253], v[240:241], s[70:71]
    v_pk_mul_f32 v[254:255], v[242:243], s[70:71]
    v_pk_mul_f32 v[80:81], v[220:221], s[70:71]
    v_pk_mul_f32 v[82:83], v[222:223], s[70:71]
    v_pk_mul_f32 v[84:85], v[244:245], s[70:71]
    v_pk_mul_f32 v[86:87], v[246:247], s[70:71]
    v_exp_f32 v248, v248 clamp
    v_max_f32 v216, s72, v216
    v_exp_f32 v249, v249 clamp
    v_max_f32 v217, s72, v217
    v_exp_f32 v250, v250 clamp
    v_max_f32 v218, s72, v218
    v_exp_f32 v251, v251 clamp
    v_max_f32 v219, s72, v219
    v_exp_f32 v252, v252 clamp
    v_max_f32 v240, s72, v240
    v_exp_f32 v253, v253 clamp
    v_max_f32 v241, s72, v241
    v_exp_f32 v254, v254 clamp
    v_max_f32 v242, s72, v242
    v_exp_f32 v255, v255 clamp
    v_max_f32 v243, s72, v243
    v_exp_f32 v80, v80 clamp
    v_max_f32 v220, s72, v220
    v_exp_f32 v81, v81 clamp
    v_max_f32 v221, s72, v221
    v_exp_f32 v82, v82 clamp
    v_max_f32 v222, s72, v222
    v_exp_f32 v83, v83 clamp
    v_max_f32 v223, s72, v223
    v_exp_f32 v84, v84 clamp
    v_max_f32 v244, s72, v244
    v_exp_f32 v85, v85 clamp
    v_max_f32 v245, s72, v245
    v_exp_f32 v86, v86 clamp
    v_max_f32 v246, s72, v246
    v_exp_f32 v87, v87 clamp
    v_max_f32 v247, s72, v247
    v_pk_add_f32 v[248:249], v[248:249], v[216:217]
    v_pk_add_f32 v[250:251], v[250:251], v[218:219]
    v_pk_add_f32 v[252:253], v[252:253], v[240:241]
    v_pk_add_f32 v[254:255], v[254:255], v[242:243]
    v_pk_add_f32 v[80:81], v[80:81], v[220:221]
    v_pk_add_f32 v[82:83], v[82:83], v[222:223]
    v_pk_add_f32 v[84:85], v[84:85], v[244:245]
    v_pk_add_f32 v[86:87], v[86:87], v[246:247]
    v_cvt_pk_bf16_f32 v216, v248, v249
    v_cvt_pk_bf16_f32 v217, v250, v251
    v_cvt_pk_bf16_f32 v218, v252, v253
    v_cvt_pk_bf16_f32 v219, v254, v255
    v_cvt_pk_bf16_f32 v220, v80, v81
    v_cvt_pk_bf16_f32 v221, v82, v83
    v_cvt_pk_bf16_f32 v222, v84, v85
    v_cvt_pk_bf16_f32 v223, v86, v87
    v_mfma_f32_16x16x32_bf16 v[240:243], v[216:219], v[224:227], 0
    s_nop 0
    v_mfma_f32_16x16x32_bf16 v[244:247], v[220:223], v[228:231], 0
    v_mfma_f32_16x16x32_bf16 v[248:251], v[76:79], v[216:219], 0
    v_mfma_f32_16x16x32_bf16 v[252:255], v[76:79], v[220:223], 0
    s_nop 3
    s_bitcmp1_b32 s11, 0
    s_cbranch_scc0 L_KVS
    s_waitcnt lgkmcnt(0)
    v_pk_mul_f32 v[176:177], v[176:177], v[96:97]
    v_pk_mul_f32 v[178:179], v[178:179], v[98:99]
    v_pk_mul_f32 v[200:201], v[200:201], v[100:101]
    v_pk_mul_f32 v[202:203], v[202:203], v[102:103]
    v_pk_mul_f32 v[180:181], v[180:181], v[96:97]
    v_pk_mul_f32 v[182:183], v[182:183], v[98:99]
    v_pk_mul_f32 v[204:205], v[204:205], v[100:101]
    v_pk_mul_f32 v[206:207], v[206:207], v[102:103]
    v_pk_fma_f32 v[168:169], v[168:169], v[96:97], s[72:73]
    v_pk_fma_f32 v[170:171], v[170:171], v[98:99], s[72:73]
    v_pk_fma_f32 v[192:193], v[192:193], v[100:101], s[72:73]
    v_pk_fma_f32 v[194:195], v[194:195], v[102:103], s[72:73]
    v_pk_fma_f32 v[172:173], v[172:173], v[96:97], s[72:73]
    v_pk_fma_f32 v[174:175], v[174:175], v[98:99], s[72:73]
    v_pk_fma_f32 v[196:197], v[196:197], v[100:101], s[72:73]
    v_pk_fma_f32 v[198:199], v[198:199], v[102:103], s[72:73]
    v_pk_fma_f32 v[176:177], v[16:17], v[74:75], v[176:177] op_sel:[0,0,0] op_sel_hi:[1,0,1]
    v_pk_fma_f32 v[178:179], v[18:19], v[74:75], v[178:179] op_sel:[0,0,0] op_sel_hi:[1,0,1]
    v_pk_fma_f32 v[200:201], v[20:21], v[74:75], v[200:201] op_sel:[0,0,0] op_sel_hi:[1,0,1]
    v_pk_fma_f32 v[202:203], v[22:23], v[74:75], v[202:203] op_sel:[0,0,0] op_sel_hi:[1,0,1]
    v_pk_fma_f32 v[180:181], v[16:17], v[74:75], v[180:181] op_sel:[0,1,0] op_sel_hi:[1,1,1]
    v_pk_fma_f32 v[182:183], v[18:19], v[74:75], v[182:183] op_sel:[0,1,0] op_sel_hi:[1,1,1]
    v_pk_fma_f32 v[204:205], v[20:21], v[74:75], v[204:205] op_sel:[0,1,0] op_sel_hi:[1,1,1]
    v_pk_fma_f32 v[206:207], v[22:23], v[74:75], v[206:207] op_sel:[0,1,0] op_sel_hi:[1,1,1]
    v_pk_fma_f32 v[168:169], v[16:17], v[72:73], v[168:169] op_sel:[0,0,0] op_sel_hi:[1,0,1]
    v_pk_fma_f32 v[170:171], v[18:19], v[72:73], v[170:171] op_sel:[0,0,0] op_sel_hi:[1,0,1]
    v_pk_fma_f32 v[192:193], v[20:21], v[72:73], v[192:193] op_sel:[0,0,0] op_sel_hi:[1,0,1]
    v_pk_fma_f32 v[194:195], v[22:23], v[72:73], v[194:195] op_sel:[0,0,0] op_sel_hi:[1,0,1]
    v_pk_fma_f32 v[172:173], v[16:17], v[72:73], v[172:173] op_sel:[0,1,0] op_sel_hi:[1,1,1]
    v_pk_fma_f32 v[174:175], v[18:19], v[72:73], v[174:175] op_sel:[0,1,0] op_sel_hi:[1,1,1]
    v_pk_fma_f32 v[196:197], v[20:21], v[72:73], v[196:197] op_sel:[0,1,0] op_sel_hi:[1,1,1]
    v_pk_fma_f32 v[198:199], v[22:23], v[72:73], v[198:199] op_sel:[0,1,0] op_sel_hi:[1,1,1]
    v_cvt_pk_bf16_f32 v176, v176, v177
    v_cvt_pk_bf16_f32 v177, v178, v179
    v_cvt_pk_bf16_f32 v178, v200, v201
    v_cvt_pk_bf16_f32 v179, v202, v203
    v_cvt_pk_bf16_f32 v180, v180, v181
    v_cvt_pk_bf16_f32 v181, v182, v183
    v_cvt_pk_bf16_f32 v182, v204, v205
    v_cvt_pk_bf16_f32 v183, v206, v207
    v_pk_mul_f32 v[200:201], v[168:169], s[70:71]
    v_pk_mul_f32 v[202:203], v[170:171], s[70:71]
    v_pk_mul_f32 v[204:205], v[192:193], s[70:71]
    v_pk_mul_f32 v[206:207], v[194:195], s[70:71]
    v_pk_mul_f32 v[80:81], v[172:173], s[70:71]
    v_pk_mul_f32 v[82:83], v[174:175], s[70:71]
    v_pk_mul_f32 v[84:85], v[196:197], s[70:71]
    v_pk_mul_f32 v[86:87], v[198:199], s[70:71]
    v_exp_f32 v200, v200 clamp
    v_max_f32 v168, s72, v168
    v_exp_f32 v201, v201 clamp
    v_max_f32 v169, s72, v169
    v_exp_f32 v202, v202 clamp
    v_max_f32 v170, s72, v170
    v_exp_f32 v203, v203 clamp
    v_max_f32 v171, s72, v171
    v_exp_f32 v204, v204 clamp
    v_max_f32 v192, s72, v192
    v_exp_f32 v205, v205 clamp
    v_max_f32 v193, s72, v193
    v_exp_f32 v206, v206 clamp
    v_max_f32 v194, s72, v194
    v_exp_f32 v207, v207 clamp
    v_max_f32 v195, s72, v195
    v_exp_f32 v80, v80 clamp
    v_max_f32 v172, s72, v172
    v_exp_f32 v81, v81 clamp
    v_max_f32 v173, s72, v173
    v_exp_f32 v82, v82 clamp
    v_max_f32 v174, s72, v174
    v_exp_f32 v83, v83 clamp
    v_max_f32 v175, s72, v175
    v_exp_f32 v84, v84 clamp
    v_max_f32 v196, s72, v196
    v_exp_f32 v85, v85 clamp
    v_max_f32 v197, s72, v197
    v_exp_f32 v86, v86 clamp
    v_max_f32 v198, s72, v198
    v_exp_f32 v87, v87 clamp
    v_max_f32 v199, s72, v199
    v_pk_add_f32 v[200:201], v[200:201], v[168:169]
    v_pk_add_f32 v[202:203], v[202:203], v[170:171]
    v_pk_add_f32 v[204:205], v[204:205], v[192:193]
    v_pk_add_f32 v[206:207], v[206:207], v[194:195]
    v_pk_add_f32 v[80:81], v[80:81], v[172:173]
    v_pk_add_f32 v[82:83], v[82:83], v[174:175]
    v_pk_add_f32 v[84:85], v[84:85], v[196:197]
    v_pk_add_f32 v[86:87], v[86:87], v[198:199]
    v_cvt_pk_bf16_f32 v168, v200, v201
    v_cvt_pk_bf16_f32 v169, v202, v203
    v_cvt_pk_bf16_f32 v170, v204, v205
    v_cvt_pk_bf16_f32 v171, v206, v207
    v_cvt_pk_bf16_f32 v172, v80, v81
    v_cvt_pk_bf16_f32 v173, v82, v83
    v_cvt_pk_bf16_f32 v174, v84, v85
    v_cvt_pk_bf16_f32 v175, v86, v87
    v_mfma_f32_16x16x32_bf16 v[240:243], v[168:171], v[176:179], v[240:243]
    s_nop 0
    v_mfma_f32_16x16x32_bf16 v[244:247], v[172:175], v[180:183], v[244:247]
    v_mfma_f32_16x16x32_bf16 v[248:251], v[76:79], v[168:171], v[248:251]
    v_mfma_f32_16x16x32_bf16 v[252:255], v[76:79], v[172:175], v[252:255]
    s_nop 3
    v_pk_mul_f32 v[128:129], v[128:129], v[88:89]
    v_pk_mul_f32 v[130:131], v[130:131], v[90:91]
    v_pk_mul_f32 v[152:153], v[152:153], v[92:93]
    v_pk_mul_f32 v[154:155], v[154:155], v[94:95]
    v_pk_mul_f32 v[132:133], v[132:133], v[88:89]
    v_pk_mul_f32 v[134:135], v[134:135], v[90:91]
    v_pk_mul_f32 v[156:157], v[156:157], v[92:93]
    v_pk_mul_f32 v[158:159], v[158:159], v[94:95]
    v_pk_fma_f32 v[120:121], v[120:121], v[88:89], s[72:73]
    v_pk_fma_f32 v[122:123], v[122:123], v[90:91], s[72:73]
    v_pk_fma_f32 v[144:145], v[144:145], v[92:93], s[72:73]
    v_pk_fma_f32 v[146:147], v[146:147], v[94:95], s[72:73]
    v_pk_fma_f32 v[124:125], v[124:125], v[88:89], s[72:73]
    v_pk_fma_f32 v[126:127], v[126:127], v[90:91], s[72:73]
    v_pk_fma_f32 v[148:149], v[148:149], v[92:93], s[72:73]
    v_pk_fma_f32 v[150:151], v[150:151], v[94:95], s[72:73]
    v_pk_fma_f32 v[128:129], v[8:9], v[74:75], v[128:129] op_sel:[0,0,0] op_sel_hi:[1,0,1]
    v_pk_fma_f32 v[130:131], v[10:11], v[74:75], v[130:131] op_sel:[0,0,0] op_sel_hi:[1,0,1]
    v_pk_fma_f32 v[152:153], v[12:13], v[74:75], v[152:153] op_sel:[0,0,0] op_sel_hi:[1,0,1]
    v_pk_fma_f32 v[154:155], v[14:15], v[74:75], v[154:155] op_sel:[0,0,0] op_sel_hi:[1,0,1]
    v_pk_fma_f32 v[132:133], v[8:9], v[74:75], v[132:133] op_sel:[0,1,0] op_sel_hi:[1,1,1]
    v_pk_fma_f32 v[134:135], v[10:11], v[74:75], v[134:135] op_sel:[0,1,0] op_sel_hi:[1,1,1]
    v_pk_fma_f32 v[156:157], v[12:13], v[74:75], v[156:157] op_sel:[0,1,0] op_sel_hi:[1,1,1]
    v_pk_fma_f32 v[158:159], v[14:15], v[74:75], v[158:159] op_sel:[0,1,0] op_sel_hi:[1,1,1]
    v_pk_fma_f32 v[120:121], v[8:9], v[72:73], v[120:121] op_sel:[0,0,0] op_sel_hi:[1,0,1]
    v_pk_fma_f32 v[122:123], v[10:11], v[72:73], v[122:123] op_sel:[0,0,0] op_sel_hi:[1,0,1]
    v_pk_fma_f32 v[144:145], v[12:13], v[72:73], v[144:145] op_sel:[0,0,0] op_sel_hi:[1,0,1]
    v_pk_fma_f32 v[146:147], v[14:15], v[72:73], v[146:147] op_sel:[0,0,0] op_sel_hi:[1,0,1]
    v_pk_fma_f32 v[124:125], v[8:9], v[72:73], v[124:125] op_sel:[0,1,0] op_sel_hi:[1,1,1]
    v_pk_fma_f32 v[126:127], v[10:11], v[72:73], v[126:127] op_sel:[0,1,0] op_sel_hi:[1,1,1]
    v_pk_fma_f32 v[148:149], v[12:13], v[72:73], v[148:149] op_sel:[0,1,0] op_sel_hi:[1,1,1]
    v_pk_fma_f32 v[150:151], v[14:15], v[72:73], v[150:151] op_sel:[0,1,0] op_sel_hi:[1,1,1]
    v_cvt_pk_bf16_f32 v128, v128, v129
    v_cvt_pk_bf16_f32 v129, v130, v131
    v_cvt_pk_bf16_f32 v130, v152, v153
    v_cvt_pk_bf16_f32 v131, v154, v155
    v_cvt_pk_bf16_f32 v132, v132, v133
    v_cvt_pk_bf16_f32 v133, v134, v135
    v_cvt_pk_bf16_f32 v134, v156, v157
    v_cvt_pk_bf16_f32 v135, v158, v159
    v_pk_mul_f32 v[152:153], v[120:121], s[70:71]
    v_pk_mul_f32 v[154:155], v[122:123], s[70:71]
    v_pk_mul_f32 v[156:157], v[144:145], s[70:71]
    v_pk_mul_f32 v[158:159], v[146:147], s[70:71]
    v_pk_mul_f32 v[80:81], v[124:125], s[70:71]
    v_pk_mul_f32 v[82:83], v[126:127], s[70:71]
    v_pk_mul_f32 v[84:85], v[148:149], s[70:71]
    v_pk_mul_f32 v[86:87], v[150:151], s[70:71]
    v_exp_f32 v152, v152 clamp
    v_max_f32 v120, s72, v120
    v_exp_f32 v153, v153 clamp
    v_max_f32 v121, s72, v121
    v_exp_f32 v154, v154 clamp
    v_max_f32 v122, s72, v122
    v_exp_f32 v155, v155 clamp
    v_max_f32 v123, s72, v123
    v_exp_f32 v156, v156 clamp
    v_max_f32 v144, s72, v144
    v_exp_f32 v157, v157 clamp
    v_max_f32 v145, s72, v145
    v_exp_f32 v158, v158 clamp
    v_max_f32 v146, s72, v146
    v_exp_f32 v159, v159 clamp
    v_max_f32 v147, s72, v147
    v_exp_f32 v80, v80 clamp
    v_max_f32 v124, s72, v124
    v_exp_f32 v81, v81 clamp
    v_max_f32 v125, s72, v125
    v_exp_f32 v82, v82 clamp
    v_max_f32 v126, s72, v126
    v_exp_f32 v83, v83 clamp
    v_max_f32 v127, s72, v127
    v_exp_f32 v84, v84 clamp
    v_max_f32 v148, s72, v148
    v_exp_f32 v85, v85 clamp
    v_max_f32 v149, s72, v149
    v_exp_f32 v86, v86 clamp
    v_max_f32 v150, s72, v150
    v_exp_f32 v87, v87 clamp
    v_max_f32 v151, s72, v151
    v_pk_add_f32 v[152:153], v[152:153], v[120:121]
    v_pk_add_f32 v[154:155], v[154:155], v[122:123]
    v_pk_add_f32 v[156:157], v[156:157], v[144:145]
    v_pk_add_f32 v[158:159], v[158:159], v[146:147]
    v_pk_add_f32 v[80:81], v[80:81], v[124:125]
    v_pk_add_f32 v[82:83], v[82:83], v[126:127]
    v_pk_add_f32 v[84:85], v[84:85], v[148:149]
    v_pk_add_f32 v[86:87], v[86:87], v[150:151]
    v_cvt_pk_bf16_f32 v120, v152, v153
    v_cvt_pk_bf16_f32 v121, v154, v155
    v_cvt_pk_bf16_f32 v122, v156, v157
    v_cvt_pk_bf16_f32 v123, v158, v159
    v_cvt_pk_bf16_f32 v124, v80, v81
    v_cvt_pk_bf16_f32 v125, v82, v83
    v_cvt_pk_bf16_f32 v126, v84, v85
    v_cvt_pk_bf16_f32 v127, v86, v87
    v_mfma_f32_16x16x32_bf16 v[240:243], v[120:123], v[128:131], v[240:243]
    s_nop 0
    v_mfma_f32_16x16x32_bf16 v[244:247], v[124:127], v[132:135], v[244:247]
    v_mfma_f32_16x16x32_bf16 v[248:251], v[76:79], v[120:123], v[248:251]
    v_mfma_f32_16x16x32_bf16 v[252:255], v[76:79], v[124:127], v[252:255]
L_KVS:
    s_waitcnt lgkmcnt(0)
    v_mov_b32 v99, s10
    v_mov_b32 v103, s10
    v_mov_b32 v107, s10
    s_nop 4
    v_permlane16_swap_b32 v240, v244
    v_permlane16_swap_b32 v241, v245
    v_permlane16_swap_b32 v242, v246
    v_permlane16_swap_b32 v243, v247
    v_mov_b32 v96, v240
    v_mov_b32 v97, v241
    v_mov_b32 v98, v242
    v_mov_b32 v100, v243
    v_mov_b32 v101, v244
    v_mov_b32 v102, v245
    v_mov_b32 v104, v246
    v_mov_b32 v105, v247
    v_cndmask_b32 v106, v248, v252, s[74:75]
    buffer_store_dwordx4 v[96:99], v6, s[44:47], s78 offen offset:0 sc1
    buffer_store_dwordx4 v[100:103], v6, s[44:47], s78 offen offset:1024 sc1
    buffer_store_dwordx4 v[104:107], v6, s[44:47], s78 offen offset:2048 sc1
    s_waitcnt lgkmcnt(0)
    v_mfma_f32_16x16x32_bf16 v[112:115], v[64:67], v[40:43], v[112:115]
    ds_read_b64_tr_b16 v[72:73], v4 offset:6144
    ds_read_b64_tr_b16 v[74:75], v4 offset:6656
    v_mfma_f32_16x16x32_bf16 v[116:119], v[68:71], v[40:43], v[116:119]
    ds_read_b64_tr_b16 v[76:77], v5 offset:6144
    ds_read_b64_tr_b16 v[78:79], v5 offset:6656
    v_mfma_f32_16x16x32_bf16 v[136:139], v[64:67], v[44:47], v[136:139]
    ds_read_b128 v[8:11], v3 offset:0
    ds_read_b128 v[12:15], v3 offset:2048
    v_mfma_f32_16x16x32_bf16 v[140:143], v[68:71], v[44:47], v[140:143]
    ds_read_b128 v[16:19], v3 offset:4096
    ds_read_b128 v[20:23], v3 offset:6144
    v_mfma_f32_16x16x32_bf16 v[160:163], v[64:67], v[48:51], v[160:163]
    ds_read_b128 v[24:27], v3 offset:8192
    ds_read_b128 v[28:31], v3 offset:10240
    v_mfma_f32_16x16x32_bf16 v[164:167], v[68:71], v[48:51], v[164:167]
    s_lshr_b32 s79, s6, 1
    s_lshl_b32 s86, s79, 8
    v_mfma_f32_16x16x32_bf16 v[184:187], v[64:67], v[52:55], v[184:187]
    s_add_u32 s86, s86, s77
    v_lshrrev_b32 v7, 4, v0
    v_mfma_f32_16x16x32_bf16 v[188:191], v[68:71], v[52:55], v[188:191]
    v_mul_u32_u24 v7, 3072, v7
    v_and_b32 v132, 15, v0
    v_mfma_f32_16x16x32_bf16 v[208:211], v[64:67], v[56:59], v[208:211]
    v_lshl_add_u32 v7, v132, 4, v7
    v_add_u32 v7, s86, v7
    v_mfma_f32_16x16x32_bf16 v[212:215], v[68:71], v[56:59], v[212:215]
    v_mov_b32 v240, 0
    v_mov_b32 v241, 0
    v_mfma_f32_16x16x32_bf16 v[232:235], v[64:67], v[60:63], v[232:235]
    v_mov_b32 v242, 0
    v_mfma_f32_16x16x32_bf16 v[236:239], v[68:71], v[60:63], v[236:239]
    s_waitcnt lgkmcnt(0)
    v_mfma_f32_16x16x32_bf16 v[112:115], v[72:75], v[8:11], v[112:115]
    ds_read_b64_tr_b16 v[64:65], v32 offset:0
    ds_read_b64_tr_b16 v[66:67], v32 offset:512
    ds_read_b64_tr_b16 v[68:69], v33 offset:0
    v_mfma_f32_16x16x32_bf16 v[116:119], v[76:79], v[8:11], v[116:119]
    ds_read_b64_tr_b16 v[70:71], v33 offset:512
    ds_read_b128 v[40:43], v2 offset:49152
    ds_read_b128 v[44:47], v2 offset:51200
    v_mfma_f32_16x16x32_bf16 v[136:139], v[72:75], v[12:15], v[136:139]
    ds_read_b128 v[48:51], v2 offset:53248
    ds_read_b128 v[52:55], v2 offset:55296
    ds_read_b128 v[56:59], v2 offset:57344
    v_mfma_f32_16x16x32_bf16 v[140:143], v[76:79], v[12:15], v[140:143]
    ds_read_b128 v[60:63], v2 offset:59392
    v_mov_b32 v243, s10
    v_mov_b32 v244, 0
    v_mfma_f32_16x16x32_bf16 v[160:163], v[72:75], v[16:19], v[160:163]
    v_mov_b32 v245, 0
    v_mov_b32 v246, 0
    v_mov_b32 v247, s10
    v_mfma_f32_16x16x32_bf16 v[164:167], v[76:79], v[16:19], v[164:167]
    v_mov_b32 v248, 0
    v_mov_b32 v249, 0
    v_mov_b32 v250, 0
    v_mfma_f32_16x16x32_bf16 v[184:187], v[72:75], v[20:23], v[184:187]
    v_mov_b32 v251, s10
    s_and_b32 s78, s6, 9
    s_add_u32 s78, s78, 2
    v_mfma_f32_16x16x32_bf16 v[188:191], v[76:79], v[20:23], v[188:191]
    ds_read_b128 v[108:111], v34 offset:1280
    ds_read_b128 v[104:107], v34 offset:1024
    ds_read_b128 v[100:103], v34 offset:768
    v_mfma_f32_16x16x32_bf16 v[208:211], v[72:75], v[24:27], v[208:211]
    ds_read_b128 v[96:99], v34 offset:512
    v_mfma_f32_16x16x32_bf16 v[212:215], v[76:79], v[24:27], v[212:215]
    v_mfma_f32_16x16x32_bf16 v[232:235], v[72:75], v[28:31], v[232:235]
    v_mfma_f32_16x16x32_bf16 v[236:239], v[76:79], v[28:31], v[236:239]
    s_waitcnt lgkmcnt(0)
    v_mfma_f32_16x16x32_bf16 v[112:115], v[64:67], v[40:43], v[112:115]
    ds_read_b64_tr_b16 v[72:73], v32 offset:6144
    ds_read_b64_tr_b16 v[74:75], v32 offset:6656
    v_mfma_f32_16x16x32_bf16 v[116:119], v[68:71], v[40:43], v[116:119]
    ds_read_b64_tr_b16 v[76:77], v33 offset:6144
    ds_read_b64_tr_b16 v[78:79], v33 offset:6656
    v_mfma_f32_16x16x32_bf16 v[136:139], v[64:67], v[44:47], v[136:139]
    ds_read_b128 v[8:11], v3 offset:49152
    ds_read_b128 v[12:15], v3 offset:51200
    v_mfma_f32_16x16x32_bf16 v[140:143], v[68:71], v[44:47], v[140:143]
    ds_read_b128 v[16:19], v3 offset:53248
    ds_read_b128 v[20:23], v3 offset:55296
    v_mfma_f32_16x16x32_bf16 v[160:163], v[64:67], v[48:51], v[160:163]
    ds_read_b128 v[24:27], v3 offset:57344
    ds_read_b128 v[28:31], v3 offset:59392
    v_mfma_f32_16x16x32_bf16 v[164:167], v[68:71], v[48:51], v[164:167]
    ds_read_b128 v[92:95], v34 offset:256
    ds_read_b128 v[88:91], v34 offset:0
    v_mfma_f32_16x16x32_bf16 v[184:187], v[64:67], v[52:55], v[184:187]
    ds_read_b128 v[80:83], v35
    ds_read_b128 v[84:87], v35 offset:64
    v_mfma_f32_16x16x32_bf16 v[188:191], v[68:71], v[52:55], v[188:191]
    v_mfma_f32_16x16x32_bf16 v[208:211], v[64:67], v[56:59], v[208:211]
    v_mfma_f32_16x16x32_bf16 v[212:215], v[68:71], v[56:59], v[212:215]
    v_mfma_f32_16x16x32_bf16 v[232:235], v[64:67], v[60:63], v[232:235]
    v_mfma_f32_16x16x32_bf16 v[236:239], v[68:71], v[60:63], v[236:239]
    s_waitcnt lgkmcnt(0)
    v_mfma_f32_16x16x32_bf16 v[232:235], v[72:75], v[28:31], v[232:235]
    v_mov_b32 v32, 152872
    v_mov_b32 v33, 1
    s_mov_b64 exec, 1
    ds_add_u32 v32, v33
    s_mov_b64 exec, -1
    v_mfma_f32_16x16x32_bf16 v[236:239], v[76:79], v[28:31], v[236:239]
    v_mfma_f32_16x16x32_bf16 v[208:211], v[72:75], v[24:27], v[208:211]
    v_mfma_f32_16x16x32_bf16 v[212:215], v[76:79], v[24:27], v[212:215]
    v_mfma_f32_16x16x32_bf16 v[184:187], v[72:75], v[20:23], v[184:187]
    v_mfma_f32_16x16x32_bf16 v[188:191], v[76:79], v[20:23], v[188:191]
    v_mfma_f32_16x16x32_bf16 v[160:163], v[72:75], v[16:19], v[160:163]
    v_mfma_f32_16x16x32_bf16 v[164:167], v[76:79], v[16:19], v[164:167]
    v_mfma_f32_16x16x32_bf16 v[136:139], v[72:75], v[12:15], v[136:139]
    v_mfma_f32_16x16x32_bf16 v[140:143], v[76:79], v[12:15], v[140:143]
    v_mfma_f32_16x16x32_bf16 v[112:115], v[72:75], v[8:11], v[112:115]
    v_mfma_f32_16x16x32_bf16 v[116:119], v[76:79], v[8:11], v[116:119]
    s_nop 3
    v_pk_fma_f32 v[208:209], v[80:81], v[104:105], v[208:209] op_sel_hi:[1,0,1]
    v_pk_fma_f32 v[210:211], v[82:83], v[104:105], v[210:211] op_sel_hi:[1,0,1]
    v_pk_fma_f32 v[232:233], v[80:81], v[108:109], v[232:233] op_sel_hi:[1,0,1]
    v_pk_fma_f32 v[234:235], v[82:83], v[108:109], v[234:235] op_sel_hi:[1,0,1]
    v_pk_fma_f32 v[212:213], v[84:85], v[104:105], v[212:213] op_sel_hi:[1,0,1]
    v_pk_fma_f32 v[214:215], v[86:87], v[104:105], v[214:215] op_sel_hi:[1,0,1]
    v_pk_fma_f32 v[236:237], v[84:85], v[108:109], v[236:237] op_sel_hi:[1,0,1]
    v_pk_fma_f32 v[238:239], v[86:87], v[108:109], v[238:239] op_sel_hi:[1,0,1]
    v_pk_fma_f32 v[208:209], v[208:209], v[104:105], s[72:73] op_sel:[0,1,0] op_sel_hi:[1,1,1]
    v_pk_fma_f32 v[210:211], v[210:211], v[104:105], s[72:73] op_sel:[0,1,0] op_sel_hi:[1,1,1]
    v_pk_fma_f32 v[232:233], v[232:233], v[108:109], s[72:73] op_sel:[0,1,0] op_sel_hi:[1,1,1]
    v_pk_fma_f32 v[234:235], v[234:235], v[108:109], s[72:73] op_sel:[0,1,0] op_sel_hi:[1,1,1]
    v_pk_fma_f32 v[212:213], v[212:213], v[104:105], s[72:73] op_sel:[0,1,0] op_sel_hi:[1,1,1]
    v_pk_fma_f32 v[214:215], v[214:215], v[104:105], s[72:73] op_sel:[0,1,0] op_sel_hi:[1,1,1]
    v_pk_fma_f32 v[236:237], v[236:237], v[108:109], s[72:73] op_sel:[0,1,0] op_sel_hi:[1,1,1]
    v_pk_fma_f32 v[238:239], v[238:239], v[108:109], s[72:73] op_sel:[0,1,0] op_sel_hi:[1,1,1]
    v_pk_mul_f32 v[8:9], v[208:209], s[70:71]
    v_pk_mul_f32 v[10:11], v[210:211], s[70:71]
    v_pk_mul_f32 v[12:13], v[232:233], s[70:71]
    v_pk_mul_f32 v[14:15], v[234:235], s[70:71]
    v_pk_mul_f32 v[16:17], v[212:213], s[70:71]
    v_pk_mul_f32 v[18:19], v[214:215], s[70:71]
    v_pk_mul_f32 v[20:21], v[236:237], s[70:71]
    v_pk_mul_f32 v[22:23], v[238:239], s[70:71]
    v_exp_f32 v8, v8 clamp
    v_max_f32 v208, s72, v208
    v_exp_f32 v9, v9 clamp
    v_max_f32 v209, s72, v209
    v_exp_f32 v10, v10 clamp
    v_max_f32 v210, s72, v210
    v_exp_f32 v11, v11 clamp
    v_max_f32 v211, s72, v211
    v_exp_f32 v12, v12 clamp
    v_max_f32 v232, s72, v232
    v_exp_f32 v13, v13 clamp
    v_max_f32 v233, s72, v233
    v_exp_f32 v14, v14 clamp
    v_max_f32 v234, s72, v234
    v_exp_f32 v15, v15 clamp
    v_max_f32 v235, s72, v235
    v_exp_f32 v16, v16 clamp
    v_max_f32 v212, s72, v212
    v_exp_f32 v17, v17 clamp
    v_max_f32 v213, s72, v213
    v_exp_f32 v18, v18 clamp
    v_max_f32 v214, s72, v214
    v_exp_f32 v19, v19 clamp
    v_max_f32 v215, s72, v215
    v_exp_f32 v20, v20 clamp
    v_max_f32 v236, s72, v236
    v_exp_f32 v21, v21 clamp
    v_max_f32 v237, s72, v237
    v_exp_f32 v22, v22 clamp
    v_max_f32 v238, s72, v238
    v_exp_f32 v23, v23 clamp
    v_max_f32 v239, s72, v239
    v_pk_add_f32 v[8:9], v[8:9], v[208:209]
    v_pk_add_f32 v[10:11], v[10:11], v[210:211]
    v_pk_add_f32 v[12:13], v[12:13], v[232:233]
    v_pk_add_f32 v[14:15], v[14:15], v[234:235]
    v_pk_add_f32 v[16:17], v[16:17], v[212:213]
    v_pk_add_f32 v[18:19], v[18:19], v[214:215]
    v_pk_add_f32 v[20:21], v[20:21], v[236:237]
    v_pk_add_f32 v[22:23], v[22:23], v[238:239]
    v_cvt_pk_bf16_f32 v56, v8, v9
    v_cvt_pk_bf16_f32 v57, v10, v11
    v_cvt_pk_bf16_f32 v58, v12, v13
    v_cvt_pk_bf16_f32 v59, v14, v15
    v_cvt_pk_bf16_f32 v60, v16, v17
    v_cvt_pk_bf16_f32 v61, v18, v19
    v_cvt_pk_bf16_f32 v62, v20, v21
    v_cvt_pk_bf16_f32 v63, v22, v23
    v_permlane16_swap_b32 v56, v58
    v_permlane16_swap_b32 v57, v59
    v_permlane16_swap_b32 v60, v62
    v_permlane16_swap_b32 v61, v63
    buffer_store_dwordx4 v[56:59], v1, s[48:51], 0 offen offset:2048 sc1
    buffer_store_dwordx4 v[60:63], v1, s[48:51], s81 offen offset:2048 sc1
    s_cmp_eq_u32 s78, s4
    s_cbranch_scc0 L_NORI
    s_mov_b32 s86, 0
    buffer_load_dwordx4 v[120:123], v7, s[44:47], s86 offen offset:0 sc1
    buffer_load_dwordx4 v[124:127], v7, s[44:47], s86 offen offset:1024 sc1
    buffer_load_dwordx4 v[128:131], v7, s[44:47], s86 offen offset:2048 sc1
    s_mov_b32 s86, 12288
    buffer_load_dwordx4 v[144:147], v7, s[44:47], s86 offen offset:0 sc1
    buffer_load_dwordx4 v[148:151], v7, s[44:47], s86 offen offset:1024 sc1
    buffer_load_dwordx4 v[152:155], v7, s[44:47], s86 offen offset:2048 sc1
    s_mov_b32 s86, 24576
    buffer_load_dwordx4 v[168:171], v7, s[44:47], s86 offen offset:0 sc1
    buffer_load_dwordx4 v[172:175], v7, s[44:47], s86 offen offset:1024 sc1
    buffer_load_dwordx4 v[176:179], v7, s[44:47], s86 offen offset:2048 sc1
    s_mov_b32 s86, 36864
    buffer_load_dwordx4 v[192:195], v7, s[44:47], s86 offen offset:0 sc1
    buffer_load_dwordx4 v[196:199], v7, s[44:47], s86 offen offset:1024 sc1
    buffer_load_dwordx4 v[200:203], v7, s[44:47], s86 offen offset:2048 sc1
    s_mov_b32 s86, 49152
    buffer_load_dwordx4 v[216:219], v7, s[44:47], s86 offen offset:0 sc1
    buffer_load_dwordx4 v[220:223], v7, s[44:47], s86 offen offset:1024 sc1
    buffer_load_dwordx4 v[224:227], v7, s[44:47], s86 offen offset:2048 sc1
    s_mov_b32 s86, 61440
    s_mov_b32 exec_hi, 0
    buffer_load_dwordx4 v[240:243], v7, s[44:47], s86 offen offset:0 sc1
    buffer_load_dwordx4 v[244:247], v7, s[44:47], s86 offen offset:1024 sc1
    buffer_load_dwordx4 v[248:251], v7, s[44:47], s86 offen offset:2048 sc1
    s_mov_b32 exec_hi, -1
L_NORI:
    s_bitcmp1_b32 s11, 0
    s_cbranch_scc0 L_PUB
    v_pk_fma_f32 v[160:161], v[80:81], v[96:97], v[160:161] op_sel_hi:[1,0,1]
    v_pk_fma_f32 v[162:163], v[82:83], v[96:97], v[162:163] op_sel_hi:[1,0,1]
    v_pk_fma_f32 v[184:185], v[80:81], v[100:101], v[184:185] op_sel_hi:[1,0,1]
    v_pk_fma_f32 v[186:187], v[82:83], v[100:101], v[186:187] op_sel_hi:[1,0,1]
    v_pk_fma_f32 v[164:165], v[84:85], v[96:97], v[164:165] op_sel_hi:[1,0,1]
    v_pk_fma_f32 v[166:167], v[86:87], v[96:97], v[166:167] op_sel_hi:[1,0,1]
    v_pk_fma_f32 v[188:189], v[84:85], v[100:101], v[188:189] op_sel_hi:[1,0,1]
    v_pk_fma_f32 v[190:191], v[86:87], v[100:101], v[190:191] op_sel_hi:[1,0,1]
    v_pk_fma_f32 v[160:161], v[160:161], v[96:97], s[72:73] op_sel:[0,1,0] op_sel_hi:[1,1,1]
    v_pk_fma_f32 v[162:163], v[162:163], v[96:97], s[72:73] op_sel:[0,1,0] op_sel_hi:[1,1,1]
    v_pk_fma_f32 v[184:185], v[184:185], v[100:101], s[72:73] op_sel:[0,1,0] op_sel_hi:[1,1,1]
    v_pk_fma_f32 v[186:187], v[186:187], v[100:101], s[72:73] op_sel:[0,1,0] op_sel_hi:[1,1,1]
    v_pk_fma_f32 v[164:165], v[164:165], v[96:97], s[72:73] op_sel:[0,1,0] op_sel_hi:[1,1,1]
    v_pk_fma_f32 v[166:167], v[166:167], v[96:97], s[72:73] op_sel:[0,1,0] op_sel_hi:[1,1,1]
    v_pk_fma_f32 v[188:189], v[188:189], v[100:101], s[72:73] op_sel:[0,1,0] op_sel_hi:[1,1,1]
    v_pk_fma_f32 v[190:191], v[190:191], v[100:101], s[72:73] op_sel:[0,1,0] op_sel_hi:[1,1,1]
    v_pk_mul_f32 v[8:9], v[160:161], s[70:71]
    v_pk_mul_f32 v[10:11], v[162:163], s[70:71]
    v_pk_mul_f32 v[12:13], v[184:185], s[70:71]
    v_pk_mul_f32 v[14:15], v[186:187], s[70:71]
    v_pk_mul_f32 v[16:17], v[164:165], s[70:71]
    v_pk_mul_f32 v[18:19], v[166:167], s[70:71]
    v_pk_mul_f32 v[20:21], v[188:189], s[70:71]
    v_pk_mul_f32 v[22:23], v[190:191], s[70:71]
    v_exp_f32 v8, v8 clamp
    v_max_f32 v160, s72, v160
    v_exp_f32 v9, v9 clamp
    v_max_f32 v161, s72, v161
    v_exp_f32 v10, v10 clamp
    v_max_f32 v162, s72, v162
    v_exp_f32 v11, v11 clamp
    v_max_f32 v163, s72, v163
    v_exp_f32 v12, v12 clamp
    v_max_f32 v184, s72, v184
    v_exp_f32 v13, v13 clamp
    v_max_f32 v185, s72, v185
    v_exp_f32 v14, v14 clamp
    v_max_f32 v186, s72, v186
    v_exp_f32 v15, v15 clamp
    v_max_f32 v187, s72, v187
    v_exp_f32 v16, v16 clamp
    v_max_f32 v164, s72, v164
    v_exp_f32 v17, v17 clamp
    v_max_f32 v165, s72, v165
    v_exp_f32 v18, v18 clamp
    v_max_f32 v166, s72, v166
    v_exp_f32 v19, v19 clamp
    v_max_f32 v167, s72, v167
    v_exp_f32 v20, v20 clamp
    v_max_f32 v188, s72, v188
    v_exp_f32 v21, v21 clamp
    v_max_f32 v189, s72, v189
    v_exp_f32 v22, v22 clamp
    v_max_f32 v190, s72, v190
    v_exp_f32 v23, v23 clamp
    v_max_f32 v191, s72, v191
    v_pk_add_f32 v[8:9], v[8:9], v[160:161]
    v_pk_add_f32 v[10:11], v[10:11], v[162:163]
    v_pk_add_f32 v[12:13], v[12:13], v[184:185]
    v_pk_add_f32 v[14:15], v[14:15], v[186:187]
    v_pk_add_f32 v[16:17], v[16:17], v[164:165]
    v_pk_add_f32 v[18:19], v[18:19], v[166:167]
    v_pk_add_f32 v[20:21], v[20:21], v[188:189]
    v_pk_add_f32 v[22:23], v[22:23], v[190:191]
    v_cvt_pk_bf16_f32 v48, v8, v9
    v_cvt_pk_bf16_f32 v49, v10, v11
    v_cvt_pk_bf16_f32 v50, v12, v13
    v_cvt_pk_bf16_f32 v51, v14, v15
    v_cvt_pk_bf16_f32 v52, v16, v17
    v_cvt_pk_bf16_f32 v53, v18, v19
    v_cvt_pk_bf16_f32 v54, v20, v21
    v_cvt_pk_bf16_f32 v55, v22, v23
    v_permlane16_swap_b32 v48, v50
    v_permlane16_swap_b32 v49, v51
    v_permlane16_swap_b32 v52, v54
    v_permlane16_swap_b32 v53, v55
    buffer_store_dwordx4 v[48:51], v1, s[48:51], 0 offen offset:1024 sc1
    buffer_store_dwordx4 v[52:55], v1, s[48:51], s81 offen offset:1024 sc1
    v_pk_fma_f32 v[112:113], v[80:81], v[88:89], v[112:113] op_sel_hi:[1,0,1]
    v_pk_fma_f32 v[114:115], v[82:83], v[88:89], v[114:115] op_sel_hi:[1,0,1]
    v_pk_fma_f32 v[136:137], v[80:81], v[92:93], v[136:137] op_sel_hi:[1,0,1]
    v_pk_fma_f32 v[138:139], v[82:83], v[92:93], v[138:139] op_sel_hi:[1,0,1]
    v_pk_fma_f32 v[116:117], v[84:85], v[88:89], v[116:117] op_sel_hi:[1,0,1]
    v_pk_fma_f32 v[118:119], v[86:87], v[88:89], v[118:119] op_sel_hi:[1,0,1]
    v_pk_fma_f32 v[140:141], v[84:85], v[92:93], v[140:141] op_sel_hi:[1,0,1]
    v_pk_fma_f32 v[142:143], v[86:87], v[92:93], v[142:143] op_sel_hi:[1,0,1]
    v_pk_fma_f32 v[112:113], v[112:113], v[88:89], s[72:73] op_sel:[0,1,0] op_sel_hi:[1,1,1]
    v_pk_fma_f32 v[114:115], v[114:115], v[88:89], s[72:73] op_sel:[0,1,0] op_sel_hi:[1,1,1]
    v_pk_fma_f32 v[136:137], v[136:137], v[92:93], s[72:73] op_sel:[0,1,0] op_sel_hi:[1,1,1]
    v_pk_fma_f32 v[138:139], v[138:139], v[92:93], s[72:73] op_sel:[0,1,0] op_sel_hi:[1,1,1]
    v_pk_fma_f32 v[116:117], v[116:117], v[88:89], s[72:73] op_sel:[0,1,0] op_sel_hi:[1,1,1]
    v_pk_fma_f32 v[118:119], v[118:119], v[88:89], s[72:73] op_sel:[0,1,0] op_sel_hi:[1,1,1]
    v_pk_fma_f32 v[140:141], v[140:141], v[92:93], s[72:73] op_sel:[0,1,0] op_sel_hi:[1,1,1]
    v_pk_fma_f32 v[142:143], v[142:143], v[92:93], s[72:73] op_sel:[0,1,0] op_sel_hi:[1,1,1]
    v_pk_mul_f32 v[8:9], v[112:113], s[70:71]
    v_pk_mul_f32 v[10:11], v[114:115], s[70:71]
    v_pk_mul_f32 v[12:13], v[136:137], s[70:71]
    v_pk_mul_f32 v[14:15], v[138:139], s[70:71]
    v_pk_mul_f32 v[16:17], v[116:117], s[70:71]
    v_pk_mul_f32 v[18:19], v[118:119], s[70:71]
    v_pk_mul_f32 v[20:21], v[140:141], s[70:71]
    v_pk_mul_f32 v[22:23], v[142:143], s[70:71]
    v_exp_f32 v8, v8 clamp
    v_max_f32 v112, s72, v112
    v_exp_f32 v9, v9 clamp
    v_max_f32 v113, s72, v113
    v_exp_f32 v10, v10 clamp
    v_max_f32 v114, s72, v114
    v_exp_f32 v11, v11 clamp
    v_max_f32 v115, s72, v115
    v_exp_f32 v12, v12 clamp
    v_max_f32 v136, s72, v136
    v_exp_f32 v13, v13 clamp
    v_max_f32 v137, s72, v137
    v_exp_f32 v14, v14 clamp
    v_max_f32 v138, s72, v138
    v_exp_f32 v15, v15 clamp
    v_max_f32 v139, s72, v139
    v_exp_f32 v16, v16 clamp
    v_max_f32 v116, s72, v116
    v_exp_f32 v17, v17 clamp
    v_max_f32 v117, s72, v117
    v_exp_f32 v18, v18 clamp
    v_max_f32 v118, s72, v118
    v_exp_f32 v19, v19 clamp
    v_max_f32 v119, s72, v119
    v_exp_f32 v20, v20 clamp
    v_max_f32 v140, s72, v140
    v_exp_f32 v21, v21 clamp
    v_max_f32 v141, s72, v141
    v_exp_f32 v22, v22 clamp
    v_max_f32 v142, s72, v142
    v_exp_f32 v23, v23 clamp
    v_max_f32 v143, s72, v143
    v_pk_add_f32 v[8:9], v[8:9], v[112:113]
    v_pk_add_f32 v[10:11], v[10:11], v[114:115]
    v_pk_add_f32 v[12:13], v[12:13], v[136:137]
    v_pk_add_f32 v[14:15], v[14:15], v[138:139]
    v_pk_add_f32 v[16:17], v[16:17], v[116:117]
    v_pk_add_f32 v[18:19], v[18:19], v[118:119]
    v_pk_add_f32 v[20:21], v[20:21], v[140:141]
    v_pk_add_f32 v[22:23], v[22:23], v[142:143]
    v_cvt_pk_bf16_f32 v40, v8, v9
    v_cvt_pk_bf16_f32 v41, v10, v11
    v_cvt_pk_bf16_f32 v42, v12, v13
    v_cvt_pk_bf16_f32 v43, v14, v15
    v_cvt_pk_bf16_f32 v44, v16, v17
    v_cvt_pk_bf16_f32 v45, v18, v19
    v_cvt_pk_bf16_f32 v46, v20, v21
    v_cvt_pk_bf16_f32 v47, v22, v23
    v_permlane16_swap_b32 v40, v42
    v_permlane16_swap_b32 v41, v43
    v_permlane16_swap_b32 v44, v46
    v_permlane16_swap_b32 v45, v47
    buffer_store_dwordx4 v[40:43], v1, s[48:51], 0 offen offset:0 sc1
    buffer_store_dwordx4 v[44:47], v1, s[48:51], s81 offen offset:0 sc1
    s_cmp_eq_u32 s78, s4
    s_cbranch_scc0 L_PUB
    v_mov_b32 v2, 152864
    v_mov_b32 v3, 1
    s_mov_b64 exec, 1
    ds_add_u32 v2, v3
    s_mov_b64 exec, -1
    s_sub_u32 s86, s7, 15
    s_lshl_b32 s86, s86, 12
    s_and_b32 s87, s6, 1
    s_lshl_b32 s87, s87, 11
    s_add_u32 s86, s86, s87
    s_and_b32 s87, s6, 2
    s_lshl_b32 s87, s87, 9
    s_add_u32 s86, s86, s87
    s_lshr_b32 s87, s6, 2
    s_lshl_b32 s87, s87, 9
    s_add_u32 s86, s86, s87
    s_lshl1_add_u32 s91, s86, 393216
    s_add_u32 s86, s86, 786432
    v_lshl_add_u32 v9, v0, 4, s86
    s_mov_b32 s88, 0
    s_waitcnt vmcnt(4)
L_KVC:
    v_xor_b32 v8, s10, v123
    v_xor_b32 v65, s10, v127
    v_xor_b32 v66, s10, v131
    v_xor_b32 v67, s10, v147
    v_xor_b32 v68, s10, v151
    v_xor_b32 v69, s10, v155
    v_xor_b32 v70, s10, v171
    v_xor_b32 v71, s10, v175
    v_xor_b32 v72, s10, v179
    v_xor_b32 v73, s10, v195
    v_xor_b32 v74, s10, v199
    v_xor_b32 v75, s10, v203
    v_xor_b32 v76, s10, v219
    v_xor_b32 v77, s10, v223
    v_xor_b32 v78, s10, v227
    v_xor_b32 v79, s10, v243
    v_xor_b32 v80, s10, v247
    v_xor_b32 v81, s10, v251
    v_or3_b32 v8, v8, v65, v66
    v_or3_b32 v8, v8, v67, v68
    v_or3_b32 v8, v8, v69, v70
    v_or3_b32 v8, v8, v71, v72
    v_or3_b32 v8, v8, v73, v74
    v_or3_b32 v8, v8, v75, v76
    v_or3_b32 v8, v8, v77, v78
    v_or3_b32 v8, v8, v79, v80
    v_or_b32 v8, v8, v81
    v_cmp_ne_u32 vcc, 0, v8
    s_add_u32 s88, s88, 1
    s_cmp_gt_u32 s88, 131072
    s_cbranch_scc1 L_KVD
    s_cbranch_vccz L_KVD
    s_mov_b32 s86, 0
    buffer_load_dwordx4 v[120:123], v7, s[44:47], s86 offen offset:0 sc1
    buffer_load_dwordx4 v[124:127], v7, s[44:47], s86 offen offset:1024 sc1
    buffer_load_dwordx4 v[128:131], v7, s[44:47], s86 offen offset:2048 sc1
    s_mov_b32 s86, 12288
    buffer_load_dwordx4 v[144:147], v7, s[44:47], s86 offen offset:0 sc1
    buffer_load_dwordx4 v[148:151], v7, s[44:47], s86 offen offset:1024 sc1
    buffer_load_dwordx4 v[152:155], v7, s[44:47], s86 offen offset:2048 sc1
    s_mov_b32 s86, 24576
    buffer_load_dwordx4 v[168:171], v7, s[44:47], s86 offen offset:0 sc1
    buffer_load_dwordx4 v[172:175], v7, s[44:47], s86 offen offset:1024 sc1
    buffer_load_dwordx4 v[176:179], v7, s[44:47], s86 offen offset:2048 sc1
    s_mov_b32 s86, 36864
    buffer_load_dwordx4 v[192:195], v7, s[44:47], s86 offen offset:0 sc1
    buffer_load_dwordx4 v[196:199], v7, s[44:47], s86 offen offset:1024 sc1
    buffer_load_dwordx4 v[200:203], v7, s[44:47], s86 offen offset:2048 sc1
    s_mov_b32 s86, 49152
    buffer_load_dwordx4 v[216:219], v7, s[44:47], s86 offen offset:0 sc1
    buffer_load_dwordx4 v[220:223], v7, s[44:47], s86 offen offset:1024 sc1
    buffer_load_dwordx4 v[224:227], v7, s[44:47], s86 offen offset:2048 sc1
    s_mov_b32 s86, 61440
    s_mov_b32 exec_hi, 0
    buffer_load_dwordx4 v[240:243], v7, s[44:47], s86 offen offset:0 sc1
    buffer_load_dwordx4 v[244:247], v7, s[44:47], s86 offen offset:1024 sc1
    buffer_load_dwordx4 v[248:251], v7, s[44:47], s86 offen offset:2048 sc1
    s_mov_b32 exec_hi, -1
    s_waitcnt vmcnt(0)
    s_branch L_KVC
L_KVD:
    v_add_f32 v12, v120, v144
    v_add_f32 v13, v121, v145
    v_add_f32 v14, v122, v146
    v_add_f32 v15, v124, v148
    v_add_f32 v16, v125, v149
    v_add_f32 v17, v126, v150
    v_add_f32 v18, v128, v152
    v_add_f32 v19, v129, v153
    v_add_f32 v20, v130, v154
    v_add_f32 v12, v12, v168
    v_add_f32 v13, v13, v169
    v_add_f32 v14, v14, v170
    v_add_f32 v15, v15, v172
    v_add_f32 v16, v16, v173
    v_add_f32 v17, v17, v174
    v_add_f32 v18, v18, v176
    v_add_f32 v19, v19, v177
    v_add_f32 v20, v20, v178
    v_add_f32 v12, v12, v192
    v_add_f32 v13, v13, v193
    v_add_f32 v14, v14, v194
    v_add_f32 v15, v15, v196
    v_add_f32 v16, v16, v197
    v_add_f32 v17, v17, v198
    v_add_f32 v18, v18, v200
    v_add_f32 v19, v19, v201
    v_add_f32 v20, v20, v202
    v_add_f32 v12, v12, v216
    v_add_f32 v13, v13, v217
    v_add_f32 v14, v14, v218
    v_add_f32 v15, v15, v220
    v_add_f32 v16, v16, v221
    v_add_f32 v17, v17, v222
    v_add_f32 v18, v18, v224
    v_add_f32 v19, v19, v225
    v_add_f32 v20, v20, v226
    v_add_f32 v12, v12, v240
    v_add_f32 v13, v13, v241
    v_add_f32 v14, v14, v242
    v_add_f32 v15, v15, v244
    v_add_f32 v16, v16, v245
    v_add_f32 v17, v17, v246
    v_add_f32 v18, v18, v248
    v_add_f32 v19, v19, v249
    v_add_f32 v20, v20, v250
    v_mov_b32 v64, v12
    v_mov_b32 v65, v13
    v_mov_b32 v66, v14
    v_mov_b32 v67, v15
    v_mov_b32 v68, v16
    v_mov_b32 v69, v17
    v_mov_b32 v70, v18
    v_mov_b32 v71, v19
    v_mov_b32 v72, v20
    v_permlane16_swap_b32 v12, v64
    v_permlane16_swap_b32 v13, v65
    v_permlane16_swap_b32 v14, v66
    v_permlane16_swap_b32 v15, v67
    v_permlane16_swap_b32 v16, v68
    v_permlane16_swap_b32 v17, v69
    v_permlane16_swap_b32 v18, v70
    v_permlane16_swap_b32 v19, v71
    v_permlane16_swap_b32 v20, v72
    v_add_f32 v12, v12, v64
    v_add_f32 v13, v13, v65
    v_add_f32 v14, v14, v66
    v_add_f32 v15, v15, v67
    v_add_f32 v16, v16, v68
    v_add_f32 v17, v17, v69
    v_add_f32 v18, v18, v70
    v_add_f32 v19, v19, v71
    v_add_f32 v20, v20, v72
    v_mov_b32 v64, v12
    v_mov_b32 v65, v13
    v_mov_b32 v66, v14
    v_mov_b32 v67, v15
    v_mov_b32 v68, v16
    v_mov_b32 v69, v17
    v_mov_b32 v70, v18
    v_mov_b32 v71, v19
    v_mov_b32 v72, v20
    v_permlane32_swap_b32 v12, v64
    v_permlane32_swap_b32 v13, v65
    v_permlane32_swap_b32 v14, v66
    v_permlane32_swap_b32 v15, v67
    v_permlane32_swap_b32 v16, v68
    v_permlane32_swap_b32 v17, v69
    v_permlane32_swap_b32 v18, v70
    v_permlane32_swap_b32 v19, v71
    v_permlane32_swap_b32 v20, v72
    v_add_f32 v12, v12, v64
    v_add_f32 v13, v13, v65
    v_add_f32 v14, v14, v66
    v_add_f32 v15, v15, v67
    v_add_f32 v16, v16, v68
    v_add_f32 v17, v17, v69
    v_add_f32 v18, v18, v70
    v_add_f32 v19, v19, v71
    v_add_f32 v20, v20, v72
    s_lshr_b32 s86, s79, 1
    s_lshl_b32 s86, s86, 3
    s_add_u32 s87, s86, 2
    s_add_u32 s88, s86, 4
    s_add_u32 s89, s86, 6
    v_mov_b32_dpp v21, v20 row_shl:1 row_mask:0xf bank_mask:0xf
    v_cvt_pk_bf16_f32 v64, v12, v13
    v_cvt_pk_bf16_f32 v65, v14, v15
    v_cvt_pk_bf16_f32 v66, v16, v17
    v_cvt_pk_bf16_f32 v67, v18, v19
    v_cvt_pk_bf16_f32 v21, v20, v21
    s_bitcmp1_b32 s79, 0
    s_cselect_b64 s[80:81], -1, 0
    s_xor_b64 s[80:81], s[80:81], s[74:75]
    v_readlane_b32 s70, v21, s86
    v_readlane_b32 s71, v21, s87
    v_readlane_b32 s72, v21, s88
    v_readlane_b32 s73, v21, s89
    v_mov_b32 v68, s70
    v_mov_b32 v69, s71
    v_mov_b32 v70, s72
    v_mov_b32 v71, s73
    v_cndmask_b32 v72, v64, v68, s[80:81]
    v_cndmask_b32 v73, v65, v69, s[80:81]
    v_cndmask_b32 v74, v66, v70, s[80:81]
    v_cndmask_b32 v75, v67, v71, s[80:81]
    s_mov_b32 exec_hi, 0
    buffer_store_dwordx4 v[72:75], v9, s[44:47], 0 offen sc1
    s_mov_b32 exec_hi, -1
    s_waitcnt vmcnt(1)
    s_add_u32 s86, s15, 2097152
    s_mov_b64 exec, 0xffff
    buffer_store_dwordx4 v[36:39], v6, s[44:47], s86 offen sc1
    s_mov_b64 exec, -1
L_SPART:
    s_lshl_b32 s86, s4, 4
    s_lshl_b32 s87, s84, 6
    s_add_u32 s86, s86, s87
    s_add_u32 s86, s86, 8
    s_lshl_b32 s86, s86, 10
    s_lshl_b32 s87, s85, 7
    s_add_u32 s86, s86, s87
    v_lshrrev_b32 v8, 3, v0
    v_lshlrev_b32 v8, 10, v8
    v_and_b32 v9, 7, v0
    v_lshl_add_u32 v8, v9, 4, v8
    v_add_u32 v1, s86, v8
    buffer_load_dwordx4 v[12:15], v1, s[36:39], 0 offen
    v_and_b32 v8, 3, v0
    v_bfe_u32 v9, v0, 2, 2
    v_bfe_u32 v10, v0, 4, 1
    v_lshrrev_b32 v11, 5, v0
    v_lshl_add_u32 v11, v11, 2, v9
    v_lshlrev_b32 v11, 7, v11
    v_lshrrev_b32 v9, 1, v9
    v_lshl_add_u32 v10, v9, 2, v10
    v_and_b32 v9, 1, v8
    v_lshl_add_u32 v10, v9, 1, v10
    v_lshl_add_u32 v11, v10, 4, v11
    v_lshrrev_b32 v8, 1, v8
    v_lshl_add_u32 v11, v8, 3, v11
    v_add_u32 v4, s76, v11
    v_xor_b32 v11, 64, v11
    v_add_u32 v5, s76, v11
    v_add_u32 v6, 98304, v4
    v_add_u32 v7, 98304, v5
    s_lshl_b32 s86, s4, 3
    s_add_u32 s86, s86, 86
    s_lshl_b32 s86, s86, 16
    s_lshl_b32 s87, s84, 11
    s_add_u32 s86, s86, s87
    v_lshl_add_u32 v2, v0, 4, s86
    s_mul_i32 s88, s84, 43
    s_lshr_b32 s88, s88, 7
    s_mul_i32 s88, s88, 23
    s_lshl_b32 s87, s4, 1
    s_add_u32 s88, s88, s87
    s_add_u32 s88, s88, 15
    s_lshl_b32 s88, s88, 12
    s_add_u32 s88, s88, 3145728
    v_and_b32 v3, 7, v0
    v_lshl_add_u32 v3, v3, 10, s88
    s_lshl_b32 s74, s4, 13
    s_add_u32 s74, s74, 786432
    v_lshl_add_u32 v8, v0, 4, s74
    s_lshl_b32 s86, s4, 2
    s_add_u32 s86, s86, 152832
    v_mov_b32 v10, s86
    s_mov_b32 s72, 0x358637bd
    s_movk_i32 s73, 4096
    s_mov_b32 s89, 0
    v_add_u32 v3, 48, v10
    s_mov_b32 s86, 0
LP_22:
    ds_read_b32 v9, v3
    s_add_u32 s86, s86, 1
    s_waitcnt lgkmcnt(0)
    v_cmp_gt_u32 vcc, 1, v9
    s_cmp_gt_u32 s86, 1048576
    s_cbranch_scc1 LPD_23
    s_cbranch_vccz LPD_23
    s_sleep 1
    s_branch LP_22
LPD_23:
    s_mov_b32 s12, 0
    s_lshl_b32 s78, s12, 2
    s_lshr_b32 s79, s12, 4
    s_xor_b32 s86, s79, 0
    buffer_load_dwordx4 v[80:83], v8, s[44:47], s86 offen offset:0 sc1
    buffer_load_dwordx4 v[84:87], v8, s[44:47], s86 offen offset:1024 sc1
    s_xor_b32 s86, s79, 2048
    buffer_load_dwordx4 v[88:91], v8, s[44:47], s86 offen offset:0 sc1
    buffer_load_dwordx4 v[92:95], v8, s[44:47], s86 offen offset:1024 sc1
    s_xor_b32 s86, s79, 4096
    buffer_load_dwordx4 v[96:99], v8, s[44:47], s86 offen offset:0 sc1
    buffer_load_dwordx4 v[100:103], v8, s[44:47], s86 offen offset:1024 sc1
    s_xor_b32 s86, s79, 6144
    buffer_load_dwordx4 v[104:107], v8, s[44:47], s86 offen offset:0 sc1
    buffer_load_dwordx4 v[108:111], v8, s[44:47], s86 offen offset:1024 sc1
    s_xor_b32 s86, s78, 0
    buffer_load_dwordx4 v[16:19], v2, s[48:51], s86 offen sc1
    buffer_load_dwordx4 v[20:23], v2, s[48:51], s86 offen offset:1024 sc1
    s_xor_b32 s86, s78, 65536
    buffer_load_dwordx4 v[24:27], v2, s[48:51], s86 offen sc1
    buffer_load_dwordx4 v[28:31], v2, s[48:51], s86 offen offset:1024 sc1
    s_xor_b32 s86, s78, 131072
    buffer_load_dwordx4 v[32:35], v2, s[48:51], s86 offen sc1
    buffer_load_dwordx4 v[36:39], v2, s[48:51], s86 offen offset:1024 sc1
    s_waitcnt vmcnt(6)
    s_branch L_FC
    s_waitcnt vmcnt(0)
    s_branch L_FL
L_FQ:
    s_sleep 8
L_FL:
    s_xor_b32 s86, s79, 0
    buffer_load_dwordx4 v[80:83], v8, s[44:47], s86 offen offset:0 sc1
    buffer_load_dwordx4 v[84:87], v8, s[44:47], s86 offen offset:1024 sc1
    s_xor_b32 s86, s79, 2048
    buffer_load_dwordx4 v[88:91], v8, s[44:47], s86 offen offset:0 sc1
    buffer_load_dwordx4 v[92:95], v8, s[44:47], s86 offen offset:1024 sc1
    s_xor_b32 s86, s79, 4096
    buffer_load_dwordx4 v[96:99], v8, s[44:47], s86 offen offset:0 sc1
    buffer_load_dwordx4 v[100:103], v8, s[44:47], s86 offen offset:1024 sc1
    s_xor_b32 s86, s79, 6144
    buffer_load_dwordx4 v[104:107], v8, s[44:47], s86 offen offset:0 sc1
    buffer_load_dwordx4 v[108:111], v8, s[44:47], s86 offen offset:1024 sc1
    s_waitcnt vmcnt(0)
L_FC:
    s_add_u32 s89, s89, 1
    v_max3_u32 v112, v80, v84, v88
    v_max3_u32 v112, v112, v92, v96
    v_max3_u32 v112, v112, v100, v104
    v_max_u32 v112, v112, v108
    v_cmp_eq_u32 vcc, -1, v112
    s_cmp_gt_u32 s89, 131072
    s_cbranch_scc1 L_FPD
    s_cbranch_vccnz L_FQ
L_FPD:
L_PIPE:
    ds_read_b64_tr_b16 v[112:113], v4 offset:49152
    ds_read_b64_tr_b16 v[114:115], v4 offset:50176
    ds_read_b64_tr_b16 v[116:117], v5 offset:49152
    ds_read_b64_tr_b16 v[118:119], v5 offset:50176
    s_waitcnt vmcnt(4)
    v_mfma_f32_32x32x16_bf16 v[128:143], v[80:83], v[16:19], 0
    v_mfma_f32_32x32x16_bf16 v[144:159], v[80:83], v[20:23], 0
    s_xor_b32 s86, s78, 196608
    buffer_load_dwordx4 v[40:43], v2, s[48:51], s86 offen sc1
    buffer_load_dwordx4 v[44:47], v2, s[48:51], s86 offen offset:1024 sc1
    s_waitcnt vmcnt(4)
    v_mfma_f32_32x32x16_bf16 v[160:175], v[84:87], v[24:27], 0
    v_mfma_f32_32x32x16_bf16 v[176:191], v[84:87], v[28:31], 0
    s_xor_b32 s86, s78, 262144
    buffer_load_dwordx4 v[48:51], v2, s[48:51], s86 offen sc1
    buffer_load_dwordx4 v[52:55], v2, s[48:51], s86 offen offset:1024 sc1
    s_nop 1
    v_add_f32 v136, s72, v136
    v_add_f32 v152, s72, v152
    v_rcp_f32 v136, v136
    v_rcp_f32 v152, v152
    v_mul_f32 v128, v128, v136
    v_mul_f32 v129, v129, v136
    v_mul_f32 v130, v130, v136
    v_mul_f32 v131, v131, v136
    v_mul_f32 v132, v132, v136
    v_mul_f32 v133, v133, v136
    v_mul_f32 v134, v134, v136
    v_mul_f32 v135, v135, v136
    v_cvt_pk_bf16_f32 v16, v128, v129
    v_cvt_pk_bf16_f32 v17, v130, v131
    v_cvt_pk_bf16_f32 v18, v132, v133
    v_cvt_pk_bf16_f32 v19, v134, v135
    v_mul_f32 v144, v144, v152
    v_mul_f32 v145, v145, v152
    v_mul_f32 v146, v146, v152
    v_mul_f32 v147, v147, v152
    v_mul_f32 v148, v148, v152
    v_mul_f32 v149, v149, v152
    v_mul_f32 v150, v150, v152
    v_mul_f32 v151, v151, v152
    v_cvt_pk_bf16_f32 v20, v144, v145
    v_cvt_pk_bf16_f32 v21, v146, v147
    v_cvt_pk_bf16_f32 v22, v148, v149
    v_cvt_pk_bf16_f32 v23, v150, v151
    s_waitcnt lgkmcnt(0)
    v_mfma_f32_32x32x16_bf16 v[192:207], v[112:115], v[16:19], 0
    ds_read_b64_tr_b16 v[120:121], v4 offset:51200
    ds_read_b64_tr_b16 v[122:123], v4 offset:52224
    ds_read_b64_tr_b16 v[124:125], v5 offset:51200
    ds_read_b64_tr_b16 v[126:127], v5 offset:52224
    v_add_f32 v160, s72, v160
    v_mfma_f32_32x32x16_bf16 v[208:223], v[116:119], v[16:19], 0
    v_add_f32 v176, s72, v176
    v_rcp_f32 v160, v160
    v_rcp_f32 v176, v176
    v_mul_f32 v168, v168, v160
    v_mul_f32 v169, v169, v160
    v_mfma_f32_32x32x16_bf16 v[224:239], v[112:115], v[20:23], 0
    v_mul_f32 v170, v170, v160
    v_mul_f32 v171, v171, v160
    v_mul_f32 v172, v172, v160
    v_mul_f32 v173, v173, v160
    v_mul_f32 v174, v174, v160
    v_mfma_f32_32x32x16_bf16 v[240:255], v[116:119], v[20:23], 0
    v_mul_f32 v175, v175, v160
    v_cvt_pk_bf16_f32 v24, v168, v169
    v_cvt_pk_bf16_f32 v25, v170, v171
    v_cvt_pk_bf16_f32 v26, v172, v173
    v_cvt_pk_bf16_f32 v27, v174, v175
    s_waitcnt vmcnt(4)
    v_mfma_f32_32x32x16_bf16 v[128:143], v[88:91], v[32:35], 0
    v_mul_f32 v184, v184, v176
    v_mul_f32 v185, v185, v176
    v_mul_f32 v186, v186, v176
    v_mul_f32 v187, v187, v176
    v_mul_f32 v188, v188, v176
    v_mul_f32 v189, v189, v176
    v_mfma_f32_32x32x16_bf16 v[144:159], v[88:91], v[36:39], 0
    v_mul_f32 v190, v190, v176
    v_mul_f32 v191, v191, v176
    v_cvt_pk_bf16_f32 v28, v184, v185
    v_cvt_pk_bf16_f32 v29, v186, v187
    v_cvt_pk_bf16_f32 v30, v188, v189
    v_cvt_pk_bf16_f32 v31, v190, v191
    s_xor_b32 s86, s78, 327680
    buffer_load_dwordx4 v[56:59], v2, s[48:51], s86 offen sc1
    buffer_load_dwordx4 v[60:63], v2, s[48:51], s86 offen offset:1024 sc1
    s_waitcnt lgkmcnt(0)
    v_mfma_f32_32x32x16_bf16 v[192:207], v[120:123], v[24:27], v[192:207]
    ds_read_b64_tr_b16 v[112:113], v4 offset:53248
    ds_read_b64_tr_b16 v[114:115], v4 offset:54272
    ds_read_b64_tr_b16 v[116:117], v5 offset:53248
    ds_read_b64_tr_b16 v[118:119], v5 offset:54272
    v_add_f32 v136, s72, v136
    v_mfma_f32_32x32x16_bf16 v[208:223], v[124:127], v[24:27], v[208:223]
    v_add_f32 v152, s72, v152
    v_rcp_f32 v136, v136
    v_rcp_f32 v152, v152
    v_mul_f32 v128, v128, v136
    v_mul_f32 v129, v129, v136
    v_mfma_f32_32x32x16_bf16 v[224:239], v[120:123], v[28:31], v[224:239]
    v_mul_f32 v130, v130, v136
    v_mul_f32 v131, v131, v136
    v_mul_f32 v132, v132, v136
    v_mul_f32 v133, v133, v136
    v_mul_f32 v134, v134, v136
    v_mfma_f32_32x32x16_bf16 v[240:255], v[124:127], v[28:31], v[240:255]
    v_mul_f32 v135, v135, v136
    v_cvt_pk_bf16_f32 v32, v128, v129
    v_cvt_pk_bf16_f32 v33, v130, v131
    v_cvt_pk_bf16_f32 v34, v132, v133
    v_cvt_pk_bf16_f32 v35, v134, v135
    s_waitcnt vmcnt(4)
    v_mfma_f32_32x32x16_bf16 v[160:175], v[92:95], v[40:43], 0
    v_mul_f32 v144, v144, v152
    v_mul_f32 v145, v145, v152
    v_mul_f32 v146, v146, v152
    v_mul_f32 v147, v147, v152
    v_mul_f32 v148, v148, v152
    v_mul_f32 v149, v149, v152
    v_mfma_f32_32x32x16_bf16 v[176:191], v[92:95], v[44:47], 0
    v_mul_f32 v150, v150, v152
    v_mul_f32 v151, v151, v152
    v_cvt_pk_bf16_f32 v36, v144, v145
    v_cvt_pk_bf16_f32 v37, v146, v147
    v_cvt_pk_bf16_f32 v38, v148, v149
    v_cvt_pk_bf16_f32 v39, v150, v151
    s_xor_b32 s86, s78, 393216
    buffer_load_dwordx4 v[64:67], v2, s[48:51], s86 offen sc1
    buffer_load_dwordx4 v[68:71], v2, s[48:51], s86 offen offset:1024 sc1
    s_waitcnt lgkmcnt(0)
    v_mfma_f32_32x32x16_bf16 v[192:207], v[112:115], v[32:35], v[192:207]
    ds_read_b64_tr_b16 v[120:121], v4 offset:55296
    ds_read_b64_tr_b16 v[122:123], v4 offset:56320
    ds_read_b64_tr_b16 v[124:125], v5 offset:55296
    ds_read_b64_tr_b16 v[126:127], v5 offset:56320
    v_add_f32 v160, s72, v160
    v_mfma_f32_32x32x16_bf16 v[208:223], v[116:119], v[32:35], v[208:223]
    v_add_f32 v176, s72, v176
    v_rcp_f32 v160, v160
    v_rcp_f32 v176, v176
    v_mul_f32 v168, v168, v160
    v_mul_f32 v169, v169, v160
    v_mfma_f32_32x32x16_bf16 v[224:239], v[112:115], v[36:39], v[224:239]
    v_mul_f32 v170, v170, v160
    v_mul_f32 v171, v171, v160
    v_mul_f32 v172, v172, v160
    v_mul_f32 v173, v173, v160
    v_mul_f32 v174, v174, v160
    v_mfma_f32_32x32x16_bf16 v[240:255], v[116:119], v[36:39], v[240:255]
    v_mul_f32 v175, v175, v160
    v_cvt_pk_bf16_f32 v40, v168, v169
    v_cvt_pk_bf16_f32 v41, v170, v171
    v_cvt_pk_bf16_f32 v42, v172, v173
    v_cvt_pk_bf16_f32 v43, v174, v175
    s_waitcnt vmcnt(4)
    v_mfma_f32_32x32x16_bf16 v[128:143], v[96:99], v[48:51], 0
    v_mul_f32 v184, v184, v176
    v_mul_f32 v185, v185, v176
    v_mul_f32 v186, v186, v176
    v_mul_f32 v187, v187, v176
    v_mul_f32 v188, v188, v176
    v_mul_f32 v189, v189, v176
    v_mfma_f32_32x32x16_bf16 v[144:159], v[96:99], v[52:55], 0
    v_mul_f32 v190, v190, v176
    v_mul_f32 v191, v191, v176
    v_cvt_pk_bf16_f32 v44, v184, v185
    v_cvt_pk_bf16_f32 v45, v186, v187
    v_cvt_pk_bf16_f32 v46, v188, v189
    v_cvt_pk_bf16_f32 v47, v190, v191
    s_xor_b32 s86, s78, 458752
    buffer_load_dwordx4 v[72:75], v2, s[48:51], s86 offen sc1
    buffer_load_dwordx4 v[76:79], v2, s[48:51], s86 offen offset:1024 sc1
    s_waitcnt lgkmcnt(0)
    v_mfma_f32_32x32x16_bf16 v[192:207], v[120:123], v[40:43], v[192:207]
    ds_read_b64_tr_b16 v[112:113], v4 offset:57344
    ds_read_b64_tr_b16 v[114:115], v4 offset:58368
    ds_read_b64_tr_b16 v[116:117], v5 offset:57344
    ds_read_b64_tr_b16 v[118:119], v5 offset:58368
    v_add_f32 v136, s72, v136
    v_mfma_f32_32x32x16_bf16 v[208:223], v[124:127], v[40:43], v[208:223]
    v_add_f32 v152, s72, v152
    v_rcp_f32 v136, v136
    v_rcp_f32 v152, v152
    v_mul_f32 v128, v128, v136
    v_mul_f32 v129, v129, v136
    v_mfma_f32_32x32x16_bf16 v[224:239], v[120:123], v[44:47], v[224:239]
    v_mul_f32 v130, v130, v136
    v_mul_f32 v131, v131, v136
    v_mul_f32 v132, v132, v136
    v_mul_f32 v133, v133, v136
    v_mul_f32 v134, v134, v136
    v_mfma_f32_32x32x16_bf16 v[240:255], v[124:127], v[44:47], v[240:255]
    v_mul_f32 v135, v135, v136
    v_cvt_pk_bf16_f32 v48, v128, v129
    v_cvt_pk_bf16_f32 v49, v130, v131
    v_cvt_pk_bf16_f32 v50, v132, v133
    v_cvt_pk_bf16_f32 v51, v134, v135
    s_waitcnt vmcnt(4)
    v_mfma_f32_32x32x16_bf16 v[160:175], v[100:103], v[56:59], 0
    v_mul_f32 v144, v144, v152
    v_mul_f32 v145, v145, v152
    v_mul_f32 v146, v146, v152
    v_mul_f32 v147, v147, v152
    v_mul_f32 v148, v148, v152
    v_mul_f32 v149, v149, v152
    v_mfma_f32_32x32x16_bf16 v[176:191], v[100:103], v[60:63], 0
    v_mul_f32 v150, v150, v152
    v_mul_f32 v151, v151, v152
    v_cvt_pk_bf16_f32 v52, v144, v145
    v_cvt_pk_bf16_f32 v53, v146, v147
    v_cvt_pk_bf16_f32 v54, v148, v149
    v_cvt_pk_bf16_f32 v55, v150, v151
    s_waitcnt lgkmcnt(0)
    v_mfma_f32_32x32x16_bf16 v[192:207], v[112:115], v[48:51], v[192:207]
    ds_read_b64_tr_b16 v[120:121], v4 offset:59392
    ds_read_b64_tr_b16 v[122:123], v4 offset:60416
    ds_read_b64_tr_b16 v[124:125], v5 offset:59392
    ds_read_b64_tr_b16 v[126:127], v5 offset:60416
    v_add_f32 v160, s72, v160
    v_mfma_f32_32x32x16_bf16 v[208:223], v[116:119], v[48:51], v[208:223]
    v_add_f32 v176, s72, v176
    v_rcp_f32 v160, v160
    v_rcp_f32 v176, v176
    v_mul_f32 v168, v168, v160
    v_mul_f32 v169, v169, v160
    v_mfma_f32_32x32x16_bf16 v[224:239], v[112:115], v[52:55], v[224:239]
    v_mul_f32 v170, v170, v160
    v_mul_f32 v171, v171, v160
    v_mul_f32 v172, v172, v160
    v_mul_f32 v173, v173, v160
    v_mul_f32 v174, v174, v160
    v_mfma_f32_32x32x16_bf16 v[240:255], v[116:119], v[52:55], v[240:255]
    v_mul_f32 v175, v175, v160
    v_cvt_pk_bf16_f32 v56, v168, v169
    v_cvt_pk_bf16_f32 v57, v170, v171
    v_cvt_pk_bf16_f32 v58, v172, v173
    v_cvt_pk_bf16_f32 v59, v174, v175
    s_waitcnt vmcnt(2)
    v_mfma_f32_32x32x16_bf16 v[128:143], v[104:107], v[64:67], 0
    v_mul_f32 v184, v184, v176
    v_mul_f32 v185, v185, v176
    v_mul_f32 v186, v186, v176
    v_mul_f32 v187, v187, v176
    v_mul_f32 v188, v188, v176
    v_mul_f32 v189, v189, v176
    v_mfma_f32_32x32x16_bf16 v[144:159], v[104:107], v[68:71], 0
    v_mul_f32 v190, v190, v176
    v_mul_f32 v191, v191, v176
    v_cvt_pk_bf16_f32 v60, v184, v185
    v_cvt_pk_bf16_f32 v61, v186, v187
    v_cvt_pk_bf16_f32 v62, v188, v189
    v_cvt_pk_bf16_f32 v63, v190, v191
    s_waitcnt lgkmcnt(0)
    v_mfma_f32_32x32x16_bf16 v[192:207], v[120:123], v[56:59], v[192:207]
    ds_read_b64_tr_b16 v[112:113], v6 offset:8192
    ds_read_b64_tr_b16 v[114:115], v6 offset:9216
    ds_read_b64_tr_b16 v[116:117], v7 offset:8192
    ds_read_b64_tr_b16 v[118:119], v7 offset:9216
    v_add_f32 v136, s72, v136
    v_mfma_f32_32x32x16_bf16 v[208:223], v[124:127], v[56:59], v[208:223]
    v_add_f32 v152, s72, v152
    v_rcp_f32 v136, v136
    v_rcp_f32 v152, v152
    v_mul_f32 v128, v128, v136
    v_mul_f32 v129, v129, v136
    v_mfma_f32_32x32x16_bf16 v[224:239], v[120:123], v[60:63], v[224:239]
    v_mul_f32 v130, v130, v136
    v_mul_f32 v131, v131, v136
    v_mul_f32 v132, v132, v136
    v_mul_f32 v133, v133, v136
    v_mul_f32 v134, v134, v136
    v_mfma_f32_32x32x16_bf16 v[240:255], v[124:127], v[60:63], v[240:255]
    v_mul_f32 v135, v135, v136
    v_cvt_pk_bf16_f32 v64, v128, v129
    v_cvt_pk_bf16_f32 v65, v130, v131
    v_cvt_pk_bf16_f32 v66, v132, v133
    v_cvt_pk_bf16_f32 v67, v134, v135
    s_waitcnt vmcnt(0)
    v_mfma_f32_32x32x16_bf16 v[160:175], v[108:111], v[72:75], 0
    v_mul_f32 v144, v144, v152
    v_mul_f32 v145, v145, v152
    v_mul_f32 v146, v146, v152
    v_mul_f32 v147, v147, v152
    v_mul_f32 v148, v148, v152
    v_mul_f32 v149, v149, v152
    v_mfma_f32_32x32x16_bf16 v[176:191], v[108:111], v[76:79], 0
    v_mul_f32 v150, v150, v152
    v_mul_f32 v151, v151, v152
    v_cvt_pk_bf16_f32 v68, v144, v145
    v_cvt_pk_bf16_f32 v69, v146, v147
    v_cvt_pk_bf16_f32 v70, v148, v149
    v_cvt_pk_bf16_f32 v71, v150, v151
    s_waitcnt lgkmcnt(0)
    v_mfma_f32_32x32x16_bf16 v[192:207], v[112:115], v[64:67], v[192:207]
    ds_read_b64_tr_b16 v[120:121], v6 offset:10240
    ds_read_b64_tr_b16 v[122:123], v6 offset:11264
    ds_read_b64_tr_b16 v[124:125], v7 offset:10240
    ds_read_b64_tr_b16 v[126:127], v7 offset:11264
    v_add_f32 v160, s72, v160
    v_mfma_f32_32x32x16_bf16 v[208:223], v[116:119], v[64:67], v[208:223]
    v_add_f32 v176, s72, v176
    v_rcp_f32 v160, v160
    v_rcp_f32 v176, v176
    v_mul_f32 v168, v168, v160
    v_mul_f32 v169, v169, v160
    v_mfma_f32_32x32x16_bf16 v[224:239], v[112:115], v[68:71], v[224:239]
    v_mul_f32 v170, v170, v160
    v_mul_f32 v171, v171, v160
    v_mul_f32 v172, v172, v160
    v_mul_f32 v173, v173, v160
    v_mul_f32 v174, v174, v160
    v_mfma_f32_32x32x16_bf16 v[240:255], v[116:119], v[68:71], v[240:255]
    v_mul_f32 v175, v175, v160
    v_cvt_pk_bf16_f32 v72, v168, v169
    v_cvt_pk_bf16_f32 v73, v170, v171
    v_cvt_pk_bf16_f32 v74, v172, v173
    v_cvt_pk_bf16_f32 v75, v174, v175
    v_mul_f32 v184, v184, v176
    v_mul_f32 v185, v185, v176
    v_mul_f32 v186, v186, v176
    v_mul_f32 v187, v187, v176
    v_mul_f32 v188, v188, v176
    v_mul_f32 v189, v189, v176
    v_mul_f32 v190, v190, v176
    v_mul_f32 v191, v191, v176
    v_cvt_pk_bf16_f32 v76, v184, v185
    v_cvt_pk_bf16_f32 v77, v186, v187
    v_cvt_pk_bf16_f32 v78, v188, v189
    v_cvt_pk_bf16_f32 v79, v190, v191
    s_waitcnt lgkmcnt(0)
    v_mfma_f32_32x32x16_bf16 v[192:207], v[120:123], v[72:75], v[192:207]
    v_lshrrev_b32 v80, 3, v0
    v_and_b32 v80, 4, v80
    v_xor_b32 v80, v80, v0
    v_lshlrev_b32 v80, 4, v80
    v_xor_b32 v81, 32, v80
    v_xor_b32 v82, 0x80, v80
    v_xor_b32 v83, 0xa0, v80
    v_mfma_f32_32x32x16_bf16 v[208:223], v[124:127], v[72:75], v[208:223]
    v_add_u32 v80, s76, v80
    v_add_u32 v81, s76, v81
    v_add_u32 v82, s76, v82
    v_add_u32 v83, s76, v83
    v_add_u32 v84, 106496, v82
    v_add_u32 v85, 106496, v83
    s_and_b32 s70, s4, 2
    v_mfma_f32_32x32x16_bf16 v[224:239], v[120:123], v[76:79], v[224:239]
    s_lshl_b32 s70, s70, 12
    s_add_u32 s70, s70, 49152
    s_add_u32 s71, s70, 4096
    s_cmp_ge_u32 s4, 2
    s_cselect_b32 s71, 106496, s71
    v_mov_b32 v88, s70
    v_mov_b32 v89, s71
    v_mfma_f32_32x32x16_bf16 v[240:255], v[124:127], v[76:79], v[240:255]
    v_and_b32 v90, 4, v0
    v_cmp_ne_u32 vcc, 0, v90
    v_and_b32 v90, 7, v0
    v_lshrrev_b32 v91, 3, v0
    v_cndmask_b32 v88, v88, v89, vcc
    v_add_u32 v91, 8, v91
    v_lshlrev_b32 v89, 1, v90
    v_xor_b32 v91, v91, v89
    s_and_b32 s70, s4, 1
    s_lshl_b32 s70, s70, 8
    v_lshl_add_u32 v88, v91, 4, v88
    v_and_b32 v89, 2, v0
    v_lshl_add_u32 v88, v89, 8, v88
    v_and_b32 v89, 1, v0
    v_lshl_add_u32 v88, v89, 11, v88
    v_add_u32 v4, s70, v88
    s_lshl_b32 s86, s4, 11
    s_add_u32 s86, s86, 153088
    v_lshl_add_u32 v9, v0, 4, s86
    v_lshlrev_b32 v112, 16, v12
    v_and_b32 v113, 0xffff0000, v12
    v_lshlrev_b32 v114, 16, v13
    v_and_b32 v115, 0xffff0000, v13
    v_lshlrev_b32 v116, 16, v14
    v_and_b32 v117, 0xffff0000, v14
    v_lshlrev_b32 v118, 16, v15
    v_and_b32 v119, 0xffff0000, v15
    ds_write_b128 v80, v[192:195] offset:49152
    ds_write_b128 v80, v[196:199] offset:50176
    ds_write_b128 v81, v[200:203] offset:51200
    ds_write_b128 v81, v[204:207] offset:52224
    ds_write_b128 v82, v[208:211] offset:53248
    ds_write_b128 v82, v[212:215] offset:54272
    ds_write_b128 v83, v[216:219] offset:55296
    ds_write_b128 v83, v[220:223] offset:56320
    ds_write_b128 v80, v[224:227] offset:57344
    ds_write_b128 v80, v[228:231] offset:58368
    ds_write_b128 v81, v[232:235] offset:59392
    ds_write_b128 v81, v[236:239] offset:60416
    ds_write_b128 v84, v[240:243] offset:0
    ds_write_b128 v84, v[244:247] offset:1024
    ds_write_b128 v85, v[248:251] offset:2048
    ds_write_b128 v85, v[252:255] offset:3072
    s_waitcnt lgkmcnt(0)
    s_barrier
    ds_read_b128 v[88:91], v9
    ds_read_b128 v[92:95], v9 offset:1024
    s_branch L_FIN2
L_FINAL:
    s_barrier
L_FIN2:
    ds_read_b128 v[48:51], v4 offset:0
    ds_read_b128 v[52:55], v4 offset:1024
    ds_read_b128 v[56:59], v4 offset:12288
    ds_read_b128 v[60:63], v4 offset:13312
    ds_read_b128 v[64:67], v4 offset:24576
    ds_read_b128 v[68:71], v4 offset:25600
    ds_read_b128 v[72:75], v4 offset:36864
    ds_read_b128 v[76:79], v4 offset:37888
    s_waitcnt lgkmcnt(0)
    v_pk_add_f32 v[48:49], v[48:49], v[56:57]
    v_pk_add_f32 v[64:65], v[64:65], v[72:73]
    v_pk_add_f32 v[50:51], v[50:51], v[58:59]
    v_pk_add_f32 v[66:67], v[66:67], v[74:75]
    v_pk_add_f32 v[52:53], v[52:53], v[60:61]
    v_pk_add_f32 v[68:69], v[68:69], v[76:77]
    v_pk_add_f32 v[54:55], v[54:55], v[62:63]
    v_pk_add_f32 v[70:71], v[70:71], v[78:79]
    v_pk_add_f32 v[48:49], v[48:49], v[64:65]
    v_pk_add_f32 v[50:51], v[50:51], v[66:67]
    v_pk_add_f32 v[52:53], v[52:53], v[68:69]
    v_pk_add_f32 v[54:55], v[54:55], v[70:71]
    v_pk_fma_f32 v[48:49], v[48:49], v[88:89], v[112:113]
    v_pk_fma_f32 v[50:51], v[50:51], v[90:91], v[114:115]
    v_pk_fma_f32 v[52:53], v[52:53], v[92:93], v[116:117]
    v_pk_fma_f32 v[54:55], v[54:55], v[94:95], v[118:119]
    v_cvt_pk_bf16_f32 v24, v48, v49
    v_cvt_pk_bf16_f32 v25, v50, v51
    v_cvt_pk_bf16_f32 v26, v52, v53
    v_cvt_pk_bf16_f32 v27, v54, v55
    buffer_store_dwordx4 v[24:27], v1, s[64:67], 0 offen
    s_add_u32 s86, s2, s3
    s_cmp_eq_u32 s86, 0
    s_cbranch_scc0 L_NOBUMP
    v_mov_b32 v2, 0
    v_mov_b32 v3, s10
    buffer_store_dword v3, v2, s[44:47], 0 offen sc1
L_NOBUMP:
L_END:
    s_endpgm
.section .rodata,"a"
.p2align 6
.amdhsa_kernel recurrent_scan__linear_attn_block__glu_gated_geglu__prompt_kernel
  .amdhsa_next_free_vgpr 256
  .amdhsa_next_free_sgpr 102
  .amdhsa_accum_offset 256
  .amdhsa_group_segment_fixed_size 0
  .amdhsa_kernarg_size 80
  .amdhsa_user_sgpr_count 2
  .amdhsa_user_sgpr_kernarg_segment_ptr 1
  .amdhsa_system_sgpr_workgroup_id_x 1
.end_amdhsa_kernel
```
